```python
import torch

def _softmax(x, axis=-1):
    return torch.softmax(x, dim=axis)
def _gelu(x):
    return torch.nn.functional.gelu(x, approximate="tanh")
def _silu(x):
    return torch.nn.functional.silu(x)
def _sigmoid(x):
    return torch.sigmoid(x)
def _layernorm(x, axis=-1, eps=1e-5):
    m = x.mean(dim=axis, keepdim=True)
    v = x.var(dim=axis, keepdim=True, unbiased=False)
    return (x - m) / torch.sqrt(v + eps)
def _scatter_add(tgt, idx, src, axis=0):
    return tgt.clone().index_add_(axis, idx, src)
def _segment_sum(src, seg, n):
    out = torch.zeros((n,) + src.shape[1:], dtype=src.dtype)
    return out.index_add_(0, seg, src)
def _pad(x, pw):
    flat = tuple(v for pair in reversed(pw) for v in pair)
    return torch.nn.functional.pad(x, flat)

kernel_name = 'parallel_sum__grouped_kv_mqa__dense_activation_relu__prompt'

def setup_inputs():

    _w = (lambda a: (lambda t: t.to(torch.bfloat16) if t.is_floating_point() else t)(torch.as_tensor(a)))
    def _A_setup():
        B, S, D, H = 1, 2048, 512, 32
        Dh = D // H
        return {
            "x": _w((lambda *s: torch.randn(*s, dtype=torch.bfloat16) * 0.05)(B, S, D)),
            "wq": _w((lambda *s: torch.randn(*s, dtype=torch.bfloat16) * 0.2)(D, H * Dh)),
            "wk": _w((lambda *s: torch.randn(*s, dtype=torch.bfloat16) * 0.2)(D, Dh)),
            "wv": _w((lambda *s: torch.randn(*s, dtype=torch.bfloat16) * 0.1)(D, Dh)),
            "wo": _w((lambda *s: torch.randn(*s, dtype=torch.bfloat16) * 0.1)(H * Dh, D)),
        }
    _A_in = _A_setup()

    def _B_setup():
        B, S, D, Dff = 1, 2048, 512, 1376
        return {
            "x": _w((lambda *s: torch.randn(*s, dtype=torch.bfloat16) * 0.05)(B, S, D)),
            "w1": _w((lambda *s: torch.randn(*s, dtype=torch.bfloat16) * 0.1)(D, Dff)),
            "w2": _w((lambda *s: torch.randn(*s, dtype=torch.bfloat16) * 0.1)(Dff, D)),
        }
    _B_in = _B_setup()

    return {
        "A_x": _A_in["x"],
        "A_wq": _A_in["wq"],
        "A_wk": _A_in["wk"],
        "A_wv": _A_in["wv"],
        "A_wo": _A_in["wo"],
        "B_x": _B_in["x"],
        "B_w1": _B_in["w1"],
        "B_w2": _B_in["w2"],
    }

def reference(A_x, A_wq, A_wk, A_wv, A_wo, B_x, B_w1, B_w2):
    def _A_ref(x, wq, wk, wv, wo):
        B, S, D = x.shape
        H = 32
        Dh = D // H
        q = (lambda x, *d: x.permute(*d))((x @ wq).reshape(B, S, H, Dh), 0, 2, 1, 3)
        k = x @ wk
        v = x @ wv
        scores = torch.einsum("bhqd,bkd->bhqk", q, k) * (Dh ** -0.5)
        p = _softmax(scores, axis=-1)
        o = torch.einsum("bhqk,bkd->bhqd", p, v)
        return (lambda x, *d: x.permute(*d))(o, 0, 2, 1, 3).reshape(B, S, H * Dh) @ wo

    def _B_ref(x, w1, w2):
        h = torch.einsum("bsd,df->bsf", x, w1)
        zero = torch.zeros_like(h)
        h = torch.maximum(h, zero)
        return torch.einsum("bsf,fd->bsd", h, w2)

    x = A_x
    xn = _layernorm(x, axis=-1)
    return x + _A_ref(xn, A_wq, A_wk, A_wv, A_wo) + _B_ref(xn, B_w1, B_w2)
```

```asm
; @launch grid=(256,1,1) block=(768,1,1) lds=163840
.amdgcn_target "amdgcn-amd-amdhsa--gfx950"
.text
.globl parallel_sum__grouped_kv_mqa__dense_activation_relu__prompt_kernel
.p2align 8
.type parallel_sum__grouped_kv_mqa__dense_activation_relu__prompt_kernel,@function
parallel_sum__grouped_kv_mqa__dense_activation_relu__prompt_kernel:
    s_cmp_ge_u32 s2, 256
    s_cbranch_scc1 DONE
    s_load_dwordx16 s[4:19], s[0:1], 0
    s_load_dwordx4 s[20:23], s[0:1], 64
    s_load_dwordx2 s[24:25], s[0:1], 80
    s_and_b32 s26, s2, 7
    s_lshl_b32 s26, s26, 2
    s_lshr_b32 s27, s2, 3
    s_and_b32 s27, s27, 3
    s_add_u32 s26, s26, s27
    s_lshr_b32 s27, s2, 5
    v_lshrrev_b32 v1, 6, v0
    v_mov_b32 v3, 161792
    v_readfirstlane_b32 s28, v1
    v_and_b32 v1, 63, v0
    v_lshlrev_b32 v2, 4, v1
    s_lshl_b32 s29, s26, 3
    s_add_u32 s29, s29, s27
    v_lshrrev_b32 v4, 3, v1
    v_and_b32 v5, 7, v1
    v_lshlrev_b32 v6, 10, v4
    v_lshl_add_u32 v124, v5, 4, v6
    s_lshl_b32 s48, s26, 16
    s_lshl_b32 s49, s28, 13
    s_add_u32 s48, s48, s49
    s_mov_b32 s49, 0
    s_and_b32 s50, s49, 0x60
    v_xor_b32 v100, s50, v124
    s_and_b32 s49, s49, 0x380
    s_or_b32 s49, s49, s48
    s_cmp_eq_u32 s28, 11
    s_cbranch_scc0 NOINIT
    v_mov_b32 v4, 0
    v_mov_b32 v5, 0
    v_mov_b32 v6, 0
    v_mov_b32 v7, 0
    v_add_u32 v8, 161792, v2
    ds_write_b128 v8, v[4:7]
NOINIT:
    s_mov_b64 exec, 0
    s_cmp_eq_u32 s28, 11
    s_cbranch_scc1 WP2079
    s_cmp_eq_u32 s28, 8
    s_cbranch_scc1 WP1154
    s_cmp_eq_u32 s28, 0
    s_cbranch_scc1 WP220
    s_cmp_eq_u32 s28, 1
    s_cbranch_scc1 WP347
    s_cmp_eq_u32 s28, 2
    s_cbranch_scc1 WP460
    s_cmp_eq_u32 s28, 3
    s_cbranch_scc1 WP572
    s_cmp_eq_u32 s28, 4
    s_cbranch_scc1 WP2185
    s_cmp_eq_u32 s28, 5
    s_cbranch_scc1 WP2314
    s_cmp_eq_u32 s28, 9
    s_cbranch_scc1 WP2457
    s_cmp_eq_u32 s28, 10
    s_cbranch_scc1 WP2588
    s_cmp_eq_u32 s28, 6
    s_cbranch_scc1 WP1289
    s_cmp_eq_u32 s28, 7
    s_cbranch_scc1 WP1422
WRET1:
    s_mov_b64 exec, -1
    s_waitcnt lgkmcnt(0)
    s_mov_b32 s32, s4
    s_mov_b32 s33, s5
    s_mov_b32 s34, 0x200000
    s_mov_b32 s35, 0x00020000
    s_mov_b32 s36, s24
    s_mov_b32 s37, s25
    s_mov_b32 s38, 0x1000000
    s_mov_b32 s39, 0x00020000
    s_cmp_ge_u32 s28, 8
    s_cbranch_scc1 G_START
    buffer_load_dwordx4 v[128:131], v124, s[32:35], s48 offen offset:0
    buffer_load_dwordx4 v[132:135], v124, s[32:35], s48 offen offset:128
    buffer_load_dwordx4 v[136:139], v124, s[32:35], s48 offen offset:256
    buffer_load_dwordx4 v[140:143], v124, s[32:35], s48 offen offset:384
    buffer_load_dwordx4 v[144:147], v124, s[32:35], s48 offen offset:512
    buffer_load_dwordx4 v[148:151], v124, s[32:35], s48 offen offset:640
    buffer_load_dwordx4 v[152:155], v124, s[32:35], s48 offen offset:768
    buffer_load_dwordx4 v[156:159], v124, s[32:35], s48 offen offset:896
    s_mov_b32 s44, s20
    s_mov_b32 s45, s21
    s_mov_b32 s46, 0x200000
    s_mov_b32 s47, 0x00020000
    s_lshr_b32 s50, s28, 1
    s_lshr_b32 s51, s27, 1
    s_cmp_eq_u32 s50, s51
    s_cbranch_scc0 A_NOPRIO
    s_setprio 2
A_NOPRIO:
    s_lshl_b32 s51, s27, 7
    s_add_u32 s48, s48, s51
    buffer_load_dwordx4 v[120:123], v124, s[32:35], s48 offen
    s_barrier
    s_lshr_b32 s50, s28, 2
    s_lshl_b32 s50, s50, 14
    s_add_u32 s50, s50, 65536
    s_and_b32 s51, s28, 3
    s_lshl_b32 s51, s51, 7
    s_add_u32 s50, s50, s51
    v_xor_b32 v9, v4, v5
    v_lshlrev_b32 v9, 4, v9
    v_lshl_add_u32 v9, v5, 9, v9
    v_add_u32 v163, s50, v9
    s_lshl_b32 s50, s28, 6
    s_add_u32 s50, s50, 161856
    v_lshlrev_b32 v10, 3, v4
    v_add_u32 v10, s50, v10
    v_lshrrev_b32 v12, 4, v1
    v_and_b32 v13, 15, v1
    v_xor_b32 v160, v13, v12
    v_lshlrev_b32 v160, 4, v160
    v_lshl_add_u32 v160, v12, 9, v160
    s_and_b32 s50, s28, 1
    s_lshl_b32 s51, s50, 14
    s_add_u32 s51, s51, 65536
    v_add_u32 v160, s51, v160
    v_xor_b32 v161, 64, v160
    v_bfe_u32 v14, v1, 2, 2
    v_and_b32 v162, 2, v14
    v_and_b32 v15, 1, v12
    v_or_b32 v162, v162, v15
    s_lshr_b32 s51, s28, 1
    v_xor_b32 v162, s51, v162
    v_lshlrev_b32 v162, 5, v162
    v_lshl_add_u32 v14, v12, 3, v14
    v_lshl_add_u32 v162, v14, 7, v162
    v_and_b32 v15, 3, v1
    v_lshl_add_u32 v162, v15, 3, v162
    s_lshl_b32 s52, s50, 8
    s_add_u32 s52, s52, 161856
    v_lshlrev_b32 v103, 3, v13
    v_add_u32 v103, s52, v103
    s_lshl_b32 s56, s26, 1
    s_add_u32 s56, s56, s50
    s_mul_i32 s56, s56, 118
    s_lshl_b32 s57, s27, 2
    s_add_u32 s56, s56, s57
    s_add_u32 s56, s56, s51
    s_lshl_b32 s56, s56, 10
    s_add_u32 s56, s56, 0x115800
    s_lshl_b32 s57, s29, 3
    s_add_u32 s57, s57, s28
    s_lshl_b32 s57, s57, 7
    s_add_u32 s57, s57, 0xb00000
    s_mov_b32 s58, 0xffff0000
    s_mov_b32 s59, 0xffff0000
    s_mov_b32 s60, 0
    s_mov_b32 s61, 0xc2800000
    s_lshl_b32 s64, s28, 12
    v_lshrrev_b32 v126, 5, v1
    v_lshlrev_b32 v126, 9, v126
    v_and_b32 v127, 31, v1
    v_lshl_add_u32 v126, v127, 3, v126
    v_add_u32 v126, s64, v126
    v_add_u32 v127, s64, v2
    s_lshl_b32 s52, s28, 13
    s_add_u32 s52, s52, 0x40000
    s_add_u32 s53, s52, 4096
    s_mov_b32 s54, 0x3f803f80
    v_mov_b32 v112, 0
    v_mov_b32 v113, 0
    v_mov_b32 v114, 0
    v_mov_b32 v115, 0
    v_mov_b32 v28, s54
    v_mov_b32 v29, s54
    v_mov_b32 v30, s54
    v_mov_b32 v31, s54
    v_mov_b32 v35, 0xdddddddd
    v_mov_b32 v102, v2
    v_mov_b32 v11, 1
    s_waitcnt vmcnt(8)
    v_dot2c_f32_bf16 v112, s54, v128
    v_dot2c_f32_bf16 v114, v128, v128
    v_dot2c_f32_bf16 v113, s54, v129
    v_dot2c_f32_bf16 v115, v129, v129
    v_dot2c_f32_bf16 v112, s54, v130
    v_dot2c_f32_bf16 v114, v130, v130
    v_dot2c_f32_bf16 v113, s54, v131
    v_dot2c_f32_bf16 v115, v131, v131
    s_waitcnt vmcnt(7)
    v_dot2c_f32_bf16 v112, s54, v132
    v_dot2c_f32_bf16 v114, v132, v132
    v_dot2c_f32_bf16 v113, s54, v133
    v_dot2c_f32_bf16 v115, v133, v133
    v_dot2c_f32_bf16 v112, s54, v134
    v_dot2c_f32_bf16 v114, v134, v134
    v_dot2c_f32_bf16 v113, s54, v135
    v_dot2c_f32_bf16 v115, v135, v135
    s_waitcnt vmcnt(6)
    v_dot2c_f32_bf16 v112, s54, v136
    v_dot2c_f32_bf16 v114, v136, v136
    v_dot2c_f32_bf16 v113, s54, v137
    v_dot2c_f32_bf16 v115, v137, v137
    v_dot2c_f32_bf16 v112, s54, v138
    v_dot2c_f32_bf16 v114, v138, v138
    v_dot2c_f32_bf16 v113, s54, v139
    v_dot2c_f32_bf16 v115, v139, v139
    s_waitcnt vmcnt(5)
    v_dot2c_f32_bf16 v112, s54, v140
    v_dot2c_f32_bf16 v114, v140, v140
    v_dot2c_f32_bf16 v113, s54, v141
    v_dot2c_f32_bf16 v115, v141, v141
    v_dot2c_f32_bf16 v112, s54, v142
    v_dot2c_f32_bf16 v114, v142, v142
    v_dot2c_f32_bf16 v113, s54, v143
    v_dot2c_f32_bf16 v115, v143, v143
    s_waitcnt vmcnt(4)
    v_dot2c_f32_bf16 v112, s54, v144
    v_dot2c_f32_bf16 v114, v144, v144
    v_dot2c_f32_bf16 v113, s54, v145
    v_dot2c_f32_bf16 v115, v145, v145
    v_dot2c_f32_bf16 v112, s54, v146
    v_dot2c_f32_bf16 v114, v146, v146
    v_dot2c_f32_bf16 v113, s54, v147
    v_dot2c_f32_bf16 v115, v147, v147
    s_waitcnt vmcnt(3)
    v_dot2c_f32_bf16 v112, s54, v148
    v_dot2c_f32_bf16 v114, v148, v148
    v_dot2c_f32_bf16 v113, s54, v149
    v_dot2c_f32_bf16 v115, v149, v149
    v_dot2c_f32_bf16 v112, s54, v150
    v_dot2c_f32_bf16 v114, v150, v150
    v_dot2c_f32_bf16 v113, s54, v151
    v_dot2c_f32_bf16 v115, v151, v151
    s_waitcnt vmcnt(2)
    v_dot2c_f32_bf16 v112, s54, v152
    v_dot2c_f32_bf16 v114, v152, v152
    v_dot2c_f32_bf16 v113, s54, v153
    v_dot2c_f32_bf16 v115, v153, v153
    v_dot2c_f32_bf16 v112, s54, v154
    v_dot2c_f32_bf16 v114, v154, v154
    v_dot2c_f32_bf16 v113, s54, v155
    v_dot2c_f32_bf16 v115, v155, v155
WP220:
    s_cbranch_execz WRET1
    s_waitcnt vmcnt(1)
    v_dot2c_f32_bf16 v112, s54, v156
    v_dot2c_f32_bf16 v114, v156, v156
    v_dot2c_f32_bf16 v113, s54, v157
    v_dot2c_f32_bf16 v115, v157, v157
    v_dot2c_f32_bf16 v112, s54, v158
    v_dot2c_f32_bf16 v114, v158, v158
    v_dot2c_f32_bf16 v113, s54, v159
    v_dot2c_f32_bf16 v115, v159, v159
    ds_read_b32 v101, v3 offset:8
    s_nop 1
    v_add_f32 v112, v112, v113
    v_add_f32 v114, v114, v115
    s_nop 0
    v_add_f32_dpp v112, v112, v112 quad_perm:[1,0,3,2] row_mask:0xf bank_mask:0xf
    v_add_f32_dpp v114, v114, v114 quad_perm:[1,0,3,2] row_mask:0xf bank_mask:0xf
    s_nop 0
    v_add_f32_dpp v112, v112, v112 quad_perm:[2,3,0,1] row_mask:0xf bank_mask:0xf
    v_add_f32_dpp v114, v114, v114 quad_perm:[2,3,0,1] row_mask:0xf bank_mask:0xf
    s_nop 0
    v_add_f32_dpp v112, v112, v112 row_half_mirror row_mask:0xf bank_mask:0xf
    v_add_f32_dpp v114, v114, v114 row_half_mirror row_mask:0xf bank_mask:0xf
    v_mul_f32 v112, 0x3b000000, v112
    v_mul_f32 v114, 0x3b000000, v114
    v_fma_f32 v114, -v112, v112, v114
    v_max_f32 v114, 0, v114
    v_cvt_pk_bf16_f32 v114, v114, v114
    v_lshlrev_b32 v114, 16, v114
    v_add_f32 v114, 0x3727c5ac, v114
    v_cvt_pk_bf16_f32 v114, v114, v114
    v_lshlrev_b32 v114, 16, v114
    v_sqrt_f32 v114, v114
    v_cvt_pk_bf16_f32 v112, v112, v112
    v_lshlrev_b32 v112, 16, v112
    v_cvt_pk_bf16_f32 v114, v114, v114
    v_lshlrev_b32 v114, 16, v114
    v_rcp_f32 v113, v114
    s_nop 0
    v_mul_f32 v112, v112, v113
    ds_write_b64 v10, v[112:113]
    s_waitcnt lgkmcnt(1)
    v_readfirstlane_b32 s30, v101
    s_cmp_ge_u32 s30, 1
    s_cbranch_scc1 GT_1
    s_mov_b32 s31, 0x40000
SP_2:
    ds_read_b32 v101, v3 offset:8
    s_sub_u32 s31, s31, 1
    s_waitcnt lgkmcnt(0)
    v_readfirstlane_b32 s30, v101
    s_cbranch_scc1 SP_2_X
    s_cmp_ge_u32 s30, 1
    s_cbranch_scc1 SP_2_X
    s_sleep 1
    s_branch SP_2
SP_2_X:
GT_1:
    s_setprio 3
    v_mov_b32 v164, v113
    v_mov_b32 v165, v113
    v_sub_f32 v166, 0, v112
    v_sub_f32 v167, 0, v112
    v_lshlrev_b32 v4, 16, v128
    v_and_b32 v5, 0xffff0000, v128
    v_pk_fma_f32 v[4:5], v[4:5], v[164:165], v[166:167]
    v_lshlrev_b32 v6, 16, v129
    v_and_b32 v7, 0xffff0000, v129
    v_cvt_pk_bf16_f32 v128, v4, v5
    v_pk_fma_f32 v[6:7], v[6:7], v[164:165], v[166:167]
    v_lshlrev_b32 v4, 16, v130
    v_and_b32 v5, 0xffff0000, v130
    v_cvt_pk_bf16_f32 v129, v6, v7
    v_pk_fma_f32 v[4:5], v[4:5], v[164:165], v[166:167]
    v_lshlrev_b32 v6, 16, v131
    v_and_b32 v7, 0xffff0000, v131
    v_cvt_pk_bf16_f32 v130, v4, v5
    v_pk_fma_f32 v[6:7], v[6:7], v[164:165], v[166:167]
    v_lshlrev_b32 v4, 16, v132
    v_and_b32 v5, 0xffff0000, v132
    v_cvt_pk_bf16_f32 v131, v6, v7
    v_pk_fma_f32 v[4:5], v[4:5], v[164:165], v[166:167]
    ds_write_b128 v163, v[128:131] offset:0
    v_lshlrev_b32 v6, 16, v133
    v_and_b32 v7, 0xffff0000, v133
    v_cvt_pk_bf16_f32 v132, v4, v5
    v_pk_fma_f32 v[6:7], v[6:7], v[164:165], v[166:167]
    v_lshlrev_b32 v4, 16, v134
    v_and_b32 v5, 0xffff0000, v134
    v_cvt_pk_bf16_f32 v133, v6, v7
    v_pk_fma_f32 v[4:5], v[4:5], v[164:165], v[166:167]
    v_lshlrev_b32 v6, 16, v135
    v_and_b32 v7, 0xffff0000, v135
    v_cvt_pk_bf16_f32 v134, v4, v5
    v_pk_fma_f32 v[6:7], v[6:7], v[164:165], v[166:167]
    v_lshlrev_b32 v4, 16, v136
    v_and_b32 v5, 0xffff0000, v136
    v_cvt_pk_bf16_f32 v135, v6, v7
    v_pk_fma_f32 v[4:5], v[4:5], v[164:165], v[166:167]
    ds_write_b128 v163, v[132:135] offset:4096
    v_lshlrev_b32 v6, 16, v137
    v_and_b32 v7, 0xffff0000, v137
    v_cvt_pk_bf16_f32 v136, v4, v5
    v_pk_fma_f32 v[6:7], v[6:7], v[164:165], v[166:167]
    v_lshlrev_b32 v4, 16, v138
    v_and_b32 v5, 0xffff0000, v138
    v_cvt_pk_bf16_f32 v137, v6, v7
    v_pk_fma_f32 v[4:5], v[4:5], v[164:165], v[166:167]
    v_lshlrev_b32 v6, 16, v139
    v_and_b32 v7, 0xffff0000, v139
    v_cvt_pk_bf16_f32 v138, v4, v5
    v_pk_fma_f32 v[6:7], v[6:7], v[164:165], v[166:167]
    v_lshlrev_b32 v4, 16, v140
    v_and_b32 v5, 0xffff0000, v140
    v_cvt_pk_bf16_f32 v139, v6, v7
    v_pk_fma_f32 v[4:5], v[4:5], v[164:165], v[166:167]
    ds_write_b128 v163, v[136:139] offset:8192
    v_lshlrev_b32 v6, 16, v141
    v_and_b32 v7, 0xffff0000, v141
    v_cvt_pk_bf16_f32 v140, v4, v5
    v_pk_fma_f32 v[6:7], v[6:7], v[164:165], v[166:167]
    v_lshlrev_b32 v4, 16, v142
    v_and_b32 v5, 0xffff0000, v142
    v_cvt_pk_bf16_f32 v141, v6, v7
    v_pk_fma_f32 v[4:5], v[4:5], v[164:165], v[166:167]
    v_lshlrev_b32 v6, 16, v143
    v_and_b32 v7, 0xffff0000, v143
    v_cvt_pk_bf16_f32 v142, v4, v5
WP347:
    s_cbranch_execz WRET1
    v_pk_fma_f32 v[6:7], v[6:7], v[164:165], v[166:167]
    v_lshlrev_b32 v4, 16, v144
    v_and_b32 v5, 0xffff0000, v144
    v_cvt_pk_bf16_f32 v143, v6, v7
    v_pk_fma_f32 v[4:5], v[4:5], v[164:165], v[166:167]
    ds_write_b128 v163, v[140:143] offset:12288
    v_lshlrev_b32 v6, 16, v145
    v_and_b32 v7, 0xffff0000, v145
    v_cvt_pk_bf16_f32 v144, v4, v5
    v_pk_fma_f32 v[6:7], v[6:7], v[164:165], v[166:167]
    v_lshlrev_b32 v4, 16, v146
    v_and_b32 v5, 0xffff0000, v146
    v_cvt_pk_bf16_f32 v145, v6, v7
    v_pk_fma_f32 v[4:5], v[4:5], v[164:165], v[166:167]
    v_lshlrev_b32 v6, 16, v147
    v_and_b32 v7, 0xffff0000, v147
    v_cvt_pk_bf16_f32 v146, v4, v5
    v_pk_fma_f32 v[6:7], v[6:7], v[164:165], v[166:167]
    v_lshlrev_b32 v4, 16, v148
    v_and_b32 v5, 0xffff0000, v148
    v_cvt_pk_bf16_f32 v147, v6, v7
    v_pk_fma_f32 v[4:5], v[4:5], v[164:165], v[166:167]
    ds_write_b128 v163, v[144:147] offset:32768
    v_lshlrev_b32 v6, 16, v149
    v_and_b32 v7, 0xffff0000, v149
    v_cvt_pk_bf16_f32 v148, v4, v5
    v_pk_fma_f32 v[6:7], v[6:7], v[164:165], v[166:167]
    v_lshlrev_b32 v4, 16, v150
    v_and_b32 v5, 0xffff0000, v150
    v_cvt_pk_bf16_f32 v149, v6, v7
    v_pk_fma_f32 v[4:5], v[4:5], v[164:165], v[166:167]
    v_lshlrev_b32 v6, 16, v151
    v_and_b32 v7, 0xffff0000, v151
    v_cvt_pk_bf16_f32 v150, v4, v5
    v_pk_fma_f32 v[6:7], v[6:7], v[164:165], v[166:167]
    v_lshlrev_b32 v4, 16, v152
    v_and_b32 v5, 0xffff0000, v152
    v_cvt_pk_bf16_f32 v151, v6, v7
    v_pk_fma_f32 v[4:5], v[4:5], v[164:165], v[166:167]
    ds_write_b128 v163, v[148:151] offset:36864
    v_lshlrev_b32 v6, 16, v153
    v_and_b32 v7, 0xffff0000, v153
    v_cvt_pk_bf16_f32 v152, v4, v5
    v_pk_fma_f32 v[6:7], v[6:7], v[164:165], v[166:167]
    v_lshlrev_b32 v4, 16, v154
    v_and_b32 v5, 0xffff0000, v154
    v_cvt_pk_bf16_f32 v153, v6, v7
    v_pk_fma_f32 v[4:5], v[4:5], v[164:165], v[166:167]
    v_lshlrev_b32 v6, 16, v155
    v_and_b32 v7, 0xffff0000, v155
    v_cvt_pk_bf16_f32 v154, v4, v5
    v_pk_fma_f32 v[6:7], v[6:7], v[164:165], v[166:167]
    v_lshlrev_b32 v4, 16, v156
    v_and_b32 v5, 0xffff0000, v156
    v_cvt_pk_bf16_f32 v155, v6, v7
    v_pk_fma_f32 v[4:5], v[4:5], v[164:165], v[166:167]
    ds_write_b128 v163, v[152:155] offset:40960
    v_lshlrev_b32 v6, 16, v157
    v_and_b32 v7, 0xffff0000, v157
    v_cvt_pk_bf16_f32 v156, v4, v5
    v_pk_fma_f32 v[6:7], v[6:7], v[164:165], v[166:167]
    v_lshlrev_b32 v4, 16, v158
    v_and_b32 v5, 0xffff0000, v158
    v_cvt_pk_bf16_f32 v157, v6, v7
    v_pk_fma_f32 v[4:5], v[4:5], v[164:165], v[166:167]
    v_lshlrev_b32 v6, 16, v159
    v_and_b32 v7, 0xffff0000, v159
    v_cvt_pk_bf16_f32 v158, v4, v5
    v_pk_fma_f32 v[6:7], v[6:7], v[164:165], v[166:167]
    s_nop 0
    v_cvt_pk_bf16_f32 v159, v6, v7
    ds_write_b128 v163, v[156:159] offset:45056
    s_mov_b64 exec, 1
    ds_add_u32 v3, v11 offset:576
    s_mov_b64 exec, -1
    s_mov_b32 s31, 0x40000
A_F0:
    ds_read_b128 v[4:7], v3 offset:576
    s_sub_u32 s31, s31, 1
    s_waitcnt lgkmcnt(0)
    v_readfirstlane_b32 s30, v4
    s_cbranch_scc1 A_F0X
    s_cmp_ge_u32 s30, 11
    s_cbranch_scc1 A_F0X
    s_sleep 1
    s_branch A_F0
A_F0X:
    ds_read_b64_tr_b16 v[36:37], v162 offset:0
    ds_read_b64_tr_b16 v[38:39], v162 offset:512
    ds_read_b128 v[40:43], v160 offset:0
    ds_read_b128 v[44:47], v160 offset:256
    ds_read_b64_tr_b16 v[48:49], v162 offset:4096
    ds_read_b64_tr_b16 v[50:51], v162 offset:4608
    ds_read_b128 v[52:55], v161 offset:2048
    ds_read_b128 v[56:59], v161 offset:2304
    ds_read_b64_tr_b16 v[60:61], v162 offset:8192
    ds_read_b64_tr_b16 v[62:63], v162 offset:8704
    ds_read_b128 v[64:67], v160 offset:4096
    ds_read_b128 v[68:71], v160 offset:4352
    s_waitcnt lgkmcnt(8)
    ds_read_b64_tr_b16 v[72:73], v162 offset:12288
    ds_read_b64_tr_b16 v[74:75], v162 offset:12800
    ds_read_b128 v[76:79], v161 offset:6144
    ds_read_b128 v[80:83], v161 offset:6400
    buffer_load_dwordx3 v[128:130], v2, s[36:39], s52 offen offset:0 sc1
    v_mfma_f32_16x16x32_bf16 v[104:107], v[36:39], v[40:43], 0
    v_mov_b64 v[84:85], 0
    v_mfma_f32_16x16x32_bf16 v[108:111], v[36:39], v[44:47], 0
    v_mov_b64 v[86:87], 0
    s_waitcnt lgkmcnt(8)
    ds_read_b64_tr_b16 v[36:37], v162 offset:16384
    ds_read_b64_tr_b16 v[38:39], v162 offset:16896
    ds_read_b128 v[40:43], v160 offset:8192
WP460:
    s_cbranch_execz WRET1
    ds_read_b128 v[44:47], v160 offset:8448
    buffer_load_dwordx3 v[132:134], v2, s[36:39], s52 offen offset:1024 sc1
    v_mfma_f32_16x16x32_bf16 v[104:107], v[48:51], v[52:55], v[104:107]
    v_mov_b64 v[88:89], 0
    v_mfma_f32_16x16x32_bf16 v[108:111], v[48:51], v[56:59], v[108:111]
    v_mov_b64 v[90:91], 0
    s_waitcnt lgkmcnt(8)
    ds_read_b64_tr_b16 v[48:49], v162 offset:20480
    ds_read_b64_tr_b16 v[50:51], v162 offset:20992
    ds_read_b128 v[52:55], v161 offset:10240
    ds_read_b128 v[56:59], v161 offset:10496
    buffer_load_dwordx3 v[136:138], v2, s[36:39], s52 offen offset:2048 sc1
    v_mfma_f32_16x16x32_bf16 v[104:107], v[60:63], v[64:67], v[104:107]
    v_mov_b64 v[92:93], 0
    v_mfma_f32_16x16x32_bf16 v[108:111], v[60:63], v[68:71], v[108:111]
    v_mov_b64 v[94:95], 0
    s_waitcnt lgkmcnt(8)
    ds_read_b64_tr_b16 v[60:61], v162 offset:24576
    ds_read_b64_tr_b16 v[62:63], v162 offset:25088
    ds_read_b128 v[64:67], v160 offset:12288
    ds_read_b128 v[68:71], v160 offset:12544
    buffer_load_dwordx3 v[140:142], v2, s[36:39], s52 offen offset:3072 sc1
    v_mfma_f32_16x16x32_bf16 v[104:107], v[72:75], v[76:79], v[104:107]
    v_mov_b64 v[96:97], 0
    v_mfma_f32_16x16x32_bf16 v[108:111], v[72:75], v[80:83], v[108:111]
    v_and_b32 v12, 27, v1
    s_waitcnt lgkmcnt(8)
    ds_read_b64_tr_b16 v[72:73], v162 offset:28672
    ds_read_b64_tr_b16 v[74:75], v162 offset:29184
    ds_read_b128 v[76:79], v161 offset:14336
    ds_read_b128 v[80:83], v161 offset:14592
    s_mov_b64 exec, 1
    ds_add_u32 v3, v11 offset:48
    s_mov_b64 exec, -1
    buffer_load_dwordx3 v[144:146], v2, s[36:39], s53 offen offset:0 sc1
    v_mfma_f32_16x16x32_bf16 v[104:107], v[36:39], v[40:43], v[104:107]
    v_cmp_eq_u32 vcc, 0, v12
    v_mfma_f32_16x16x32_bf16 v[108:111], v[36:39], v[44:47], v[108:111]
    v_mov_b32 v13, s54
    s_waitcnt lgkmcnt(9)
    ds_read_b64_tr_b16 v[36:37], v162 offset:32768
    ds_read_b64_tr_b16 v[38:39], v162 offset:33280
    ds_read_b128 v[40:43], v160 offset:32768
    ds_read_b128 v[44:47], v160 offset:33024
    buffer_load_dwordx3 v[148:150], v2, s[36:39], s53 offen offset:1024 sc1
    v_mfma_f32_16x16x32_bf16 v[104:107], v[48:51], v[52:55], v[104:107]
    v_mov_b64 v[98:99], 0
    v_mfma_f32_16x16x32_bf16 v[108:111], v[48:51], v[56:59], v[108:111]
    v_cndmask_b32 v12, 0, v13, vcc
    s_waitcnt lgkmcnt(9)
    ds_read_b64_tr_b16 v[48:49], v162 offset:36864
    ds_read_b64_tr_b16 v[50:51], v162 offset:37376
    ds_read_b128 v[52:55], v161 offset:34816
    ds_read_b128 v[56:59], v161 offset:35072
    buffer_load_dwordx3 v[152:154], v2, s[36:39], s53 offen offset:2048 sc1
    v_mfma_f32_16x16x32_bf16 v[104:107], v[60:63], v[64:67], v[104:107]
    v_mov_b32 v13, v12
    v_mfma_f32_16x16x32_bf16 v[108:111], v[60:63], v[68:71], v[108:111]
    v_mov_b64 v[14:15], v[12:13]
    s_waitcnt lgkmcnt(9)
    ds_read_b64_tr_b16 v[60:61], v162 offset:40960
    ds_read_b64_tr_b16 v[62:63], v162 offset:41472
    ds_read_b128 v[64:67], v160 offset:36864
    ds_read_b128 v[68:71], v160 offset:37120
    buffer_load_dwordx3 v[156:158], v2, s[36:39], s53 offen offset:3072 sc1
    v_mfma_f32_16x16x32_bf16 v[104:107], v[72:75], v[76:79], v[104:107]
    v_mov_b64 v[16:17], v[12:13]
    v_mfma_f32_16x16x32_bf16 v[108:111], v[72:75], v[80:83], v[108:111]
    v_mov_b64 v[18:19], v[12:13]
    s_waitcnt lgkmcnt(8)
    ds_read_b64_tr_b16 v[72:73], v162 offset:45056
    ds_read_b64_tr_b16 v[74:75], v162 offset:45568
    ds_read_b128 v[76:79], v161 offset:38912
    ds_read_b128 v[80:83], v161 offset:39168
    v_mfma_f32_16x16x32_bf16 v[104:107], v[36:39], v[40:43], v[104:107]
    v_mov_b64 v[20:21], v[12:13]
    v_mfma_f32_16x16x32_bf16 v[108:111], v[36:39], v[44:47], v[108:111]
    v_mov_b64 v[22:23], v[12:13]
    s_waitcnt lgkmcnt(8)
    ds_read_b64_tr_b16 v[36:37], v162 offset:49152
    ds_read_b64_tr_b16 v[38:39], v162 offset:49664
    ds_read_b128 v[40:43], v160 offset:40960
    ds_read_b128 v[44:47], v160 offset:41216
    ds_read_b32 v125, v3 offset:32
    v_mfma_f32_16x16x32_bf16 v[104:107], v[48:51], v[52:55], v[104:107]
    v_mov_b64 v[24:25], v[12:13]
    v_mfma_f32_16x16x32_bf16 v[108:111], v[48:51], v[56:59], v[108:111]
    v_mov_b64 v[26:27], v[12:13]
    s_waitcnt lgkmcnt(9)
    ds_read_b64_tr_b16 v[48:49], v162 offset:53248
    ds_read_b64_tr_b16 v[50:51], v162 offset:53760
    ds_read_b128 v[52:55], v161 offset:43008
    ds_read_b128 v[56:59], v161 offset:43264
    v_mfma_f32_16x16x32_bf16 v[104:107], v[60:63], v[64:67], v[104:107]
    v_mfma_f32_16x16x32_bf16 v[108:111], v[60:63], v[68:71], v[108:111]
    s_waitcnt lgkmcnt(9)
    ds_read_b64_tr_b16 v[60:61], v162 offset:57344
    ds_read_b64_tr_b16 v[62:63], v162 offset:57856
    ds_read_b128 v[64:67], v160 offset:45056
    ds_read_b128 v[68:71], v160 offset:45312
    v_mfma_f32_16x16x32_bf16 v[104:107], v[72:75], v[76:79], v[104:107]
    v_mfma_f32_16x16x32_bf16 v[108:111], v[72:75], v[80:83], v[108:111]
    s_waitcnt lgkmcnt(8)
    ds_read_b64_tr_b16 v[72:73], v162 offset:61440
    ds_read_b64_tr_b16 v[74:75], v162 offset:61952
    ds_read_b128 v[76:79], v161 offset:47104
    ds_read_b128 v[80:83], v161 offset:47360
    s_mov_b64 exec, 1
    ds_add_u32 v3, v11 offset:4
    s_mov_b64 exec, -1
    ds_read_b32 v101, v3 offset:48
    v_mfma_f32_16x16x32_bf16 v[104:107], v[36:39], v[40:43], v[104:107]
WP572:
    s_cbranch_execz WRET1
    v_mfma_f32_16x16x32_bf16 v[108:111], v[36:39], v[44:47], v[108:111]
    s_waitcnt lgkmcnt(10)
    v_mfma_f32_16x16x32_bf16 v[104:107], v[48:51], v[52:55], v[104:107]
    v_mfma_f32_16x16x32_bf16 v[108:111], v[48:51], v[56:59], v[108:111]
    s_waitcnt lgkmcnt(6)
    v_mfma_f32_16x16x32_bf16 v[104:107], v[60:63], v[64:67], v[104:107]
    v_mfma_f32_16x16x32_bf16 v[108:111], v[60:63], v[68:71], v[108:111]
    s_waitcnt lgkmcnt(0)
    v_mfma_f32_16x16x32_bf16 v[104:107], v[72:75], v[76:79], v[104:107]
    v_mfma_f32_16x16x32_bf16 v[108:111], v[72:75], v[80:83], v[108:111]
    s_nop 6
    v_readfirstlane_b32 s55, v125
    v_cvt_pk_bf16_f32 v4, v104, v105
    v_cvt_pk_bf16_f32 v5, v106, v107
    v_cvt_pk_bf16_f32 v6, v108, v109
    v_cvt_pk_bf16_f32 v7, v110, v111
    s_mov_b32 s31, 0x1000
    s_nop 0
    v_permlane16_swap_b32 v4, v6
    v_permlane16_swap_b32 v5, v7
A_LLW:
    s_waitcnt vmcnt(0)
    v_xor_b32 v131, v125, v130
    v_xor_b32 v135, v125, v134
    v_xor_b32 v139, v125, v138
    v_xor_b32 v143, v125, v142
    v_xor_b32 v147, v125, v146
    v_xor_b32 v151, v125, v150
    v_xor_b32 v155, v125, v154
    v_xor_b32 v159, v125, v158
    v_or3_b32 v131, v131, v135, v139
    v_or3_b32 v143, v143, v147, v151
    v_or3_b32 v131, v131, v155, v159
    v_or_b32 v131, v131, v143
    v_cmp_ne_u32 vcc, 0, v131
    s_cbranch_vccz A_LLOK
    s_sub_u32 s31, s31, 1
    s_cbranch_scc1 A_LLOK
    buffer_load_dwordx3 v[128:130], v2, s[36:39], s52 offen offset:0 sc1
    buffer_load_dwordx3 v[132:134], v2, s[36:39], s52 offen offset:1024 sc1
    buffer_load_dwordx3 v[136:138], v2, s[36:39], s52 offen offset:2048 sc1
    buffer_load_dwordx3 v[140:142], v2, s[36:39], s52 offen offset:3072 sc1
    buffer_load_dwordx3 v[144:146], v2, s[36:39], s53 offen offset:0 sc1
    buffer_load_dwordx3 v[148:150], v2, s[36:39], s53 offen offset:1024 sc1
    buffer_load_dwordx3 v[152:154], v2, s[36:39], s53 offen offset:2048 sc1
    buffer_load_dwordx3 v[156:158], v2, s[36:39], s53 offen offset:3072 sc1
    s_branch A_LLW
A_LLOK:
    v_readfirstlane_b32 s30, v101
    s_cmp_ge_u32 s30, 8
    s_cbranch_scc1 GT_3
    s_mov_b32 s31, 0x40000
SP_4:
    ds_read_b32 v101, v3 offset:48
    s_sub_u32 s31, s31, 1
    s_waitcnt lgkmcnt(0)
    v_readfirstlane_b32 s30, v101
    s_cbranch_scc1 SP_4_X
    s_cmp_ge_u32 s30, 8
    s_cbranch_scc1 SP_4_X
    s_sleep 1
    s_branch SP_4
SP_4_X:
GT_3:
    ds_write_b64 v126, v[128:129] offset:0
    ds_write_b64 v126, v[132:133] offset:1280
    ds_write_b64 v126, v[136:137] offset:256
    ds_write_b64 v126, v[140:141] offset:1024
    ds_write_b64 v126, v[144:145] offset:2048
    ds_write_b64 v126, v[148:149] offset:3328
    ds_write_b64 v126, v[152:153] offset:2304
    ds_write_b64 v126, v[156:157] offset:3072
    s_mov_b64 exec, 1
    ds_add_u32 v3, v11 offset:12
    s_mov_b64 exec, -1
    ds_read_b128 v[8:11], v127
    ds_read_b128 v[112:115], v127 offset:2048
    s_waitcnt lgkmcnt(0)
    v_mfma_f32_32x32x16_bf16 v[52:67], v[8:11], v[4:7], 0
    v_mfma_f32_32x32x16_bf16 v[68:83], v[112:115], v[4:7], 0
    s_mov_b32 s31, 0x40000
SP_5:
    ds_read_b32 v101, v3 offset:12
    s_sub_u32 s31, s31, 1
    s_waitcnt lgkmcnt(0)
    v_readfirstlane_b32 s30, v101
    s_cbranch_scc1 SP_5_X
    s_cmp_ge_u32 s30, 8
    s_cbranch_scc1 SP_5_X
    s_sleep 1
    s_branch SP_5
SP_5_X:
    ds_read_b128 v[8:11], v102
    s_nop 2
    v_max3_f32 v100, v52, v53, v54
    v_max3_f32 v101, v55, v56, v57
    v_max3_f32 v100, v58, v59, v100
    v_max3_f32 v101, v60, v61, v101
    v_max3_f32 v100, v62, v63, v100
    v_max3_f32 v101, v64, v65, v101
    v_max3_f32 v100, v66, v67, v100
    v_max3_f32 v100, v68, v69, v100
    v_max3_f32 v101, v70, v71, v101
    v_max3_f32 v100, v72, v73, v100
    v_max3_f32 v101, v74, v75, v101
    v_max3_f32 v100, v76, v77, v100
    v_max3_f32 v101, v78, v79, v101
    v_max3_f32 v100, v80, v81, v100
    v_max3_f32 v101, v82, v83, v101
    v_max_f32 v100, v100, v101
A_GO:
    v_mov_b32 v101, v100
    s_mov_b64 exec, s[58:59]
    ds_read_b128 v[12:15], v102 offset:1024
    ds_read_b128 v[16:19], v102 offset:768
    s_mov_b64 exec, -1
    v_permlane32_swap_b32 v100, v101
    s_nop 1
    v_max_f32 v100, v100, v101
    v_sub_f32 v36, s61, v100
    v_sub_f32 v37, s61, v100
    v_mov_b64 v[38:39], v[36:37]
    v_mov_b64 v[40:41], v[36:37]
    v_mov_b64 v[42:43], v[36:37]
    v_mov_b64 v[44:45], v[36:37]
    v_mov_b64 v[46:47], v[36:37]
    v_mov_b64 v[48:49], v[36:37]
    v_mov_b64 v[50:51], v[36:37]
    s_waitcnt lgkmcnt(2)
    v_mfma_f32_32x32x16_bf16 v[52:67], v[8:11], v[4:7], v[36:51]
    ds_read_b128 v[8:11], v102 offset:2048
    v_mov_b64 v[76:77], 0
    v_mov_b64 v[78:79], 0
    v_mov_b64 v[80:81], 0
    v_mov_b64 v[82:83], 0
    s_mov_b32 s62, 4
    s_mov_b32 s63, 0
    s_setprio 2
    s_cmp_lt_u32 s28, 4
    s_nop 2
    s_cbranch_scc1 A_LOOPXM
    s_branch A_LOOPM
.p2align 6
A_LOOP:
    v_exp_f32 v52, v52
    v_exp_f32 v53, v53
    v_smfmac_f32_32x32x32_bf16 v[84:99], v[24:27], v[76:83], v35
    s_mov_b64 exec, s[58:59]
    ds_read_b128 v[20:23], v102 offset:7168
    ds_read_b128 v[24:27], v102 offset:6912
    s_mov_b64 exec, -1
    v_exp_f32 v54, v54
    v_exp_f32 v55, v55
    v_exp_f32 v56, v56
    v_exp_f32 v57, v57
    s_waitcnt lgkmcnt(2)
    v_mfma_f32_32x32x16_bf16 v[68:83], v[8:11], v[4:7], v[36:51]
    ds_read_b128 v[8:11], v102 offset:8192
    v_exp_f32 v58, v58
    v_exp_f32 v59, v59
    v_exp_f32 v60, v60
    v_exp_f32 v61, v61
    v_smfmac_f32_32x32x32_bf16 v[84:99], v[12:15], v[52:59], v35
    v_exp_f32 v62, v62
    v_exp_f32 v63, v63
    v_exp_f32 v64, v64
    v_exp_f32 v65, v65
    v_exp_f32 v66, v66
    v_exp_f32 v67, v67
    v_exp_f32 v68, v68
    v_exp_f32 v69, v69
    v_smfmac_f32_32x32x32_bf16 v[84:99], v[16:19], v[60:67], v35
    s_mov_b64 exec, s[58:59]
    ds_read_b128 v[12:15], v102 offset:9216
    ds_read_b128 v[16:19], v102 offset:8960
    s_mov_b64 exec, -1
    v_exp_f32 v70, v70
    v_exp_f32 v71, v71
    v_exp_f32 v72, v72
    v_exp_f32 v73, v73
    s_waitcnt lgkmcnt(2)
    v_mfma_f32_32x32x16_bf16 v[52:67], v[8:11], v[4:7], v[36:51]
    ds_read_b128 v[8:11], v102 offset:10240
    v_exp_f32 v74, v74
    v_exp_f32 v75, v75
    v_exp_f32 v76, v76
    v_exp_f32 v77, v77
    v_smfmac_f32_32x32x32_bf16 v[84:99], v[20:23], v[68:75], v35
    v_exp_f32 v78, v78
    v_exp_f32 v79, v79
    v_exp_f32 v80, v80
    v_exp_f32 v81, v81
    v_add_u32 v102, 8192, v102
    v_exp_f32 v82, v82
    v_exp_f32 v83, v83
A_LOOPM:
    v_exp_f32 v52, v52
    v_exp_f32 v53, v53
    v_smfmac_f32_32x32x32_bf16 v[84:99], v[24:27], v[76:83], v35
    s_mov_b64 exec, s[58:59]
    ds_read_b128 v[20:23], v102 offset:3072
    ds_read_b128 v[24:27], v102 offset:2816
    s_mov_b64 exec, -1
    v_exp_f32 v54, v54
    v_exp_f32 v55, v55
    v_exp_f32 v56, v56
    v_exp_f32 v57, v57
    s_waitcnt lgkmcnt(2)
    v_mfma_f32_32x32x16_bf16 v[68:83], v[8:11], v[4:7], v[36:51]
    ds_read_b128 v[8:11], v102 offset:4096
    v_exp_f32 v58, v58
    v_exp_f32 v59, v59
    v_exp_f32 v60, v60
    v_exp_f32 v61, v61
    v_smfmac_f32_32x32x32_bf16 v[84:99], v[12:15], v[52:59], v35
    v_exp_f32 v62, v62
    v_exp_f32 v63, v63
    v_exp_f32 v64, v64
    v_exp_f32 v65, v65
    v_exp_f32 v66, v66
    v_exp_f32 v67, v67
    v_exp_f32 v68, v68
    v_exp_f32 v69, v69
    v_smfmac_f32_32x32x32_bf16 v[84:99], v[16:19], v[60:67], v35
    s_mov_b64 exec, s[58:59]
    ds_read_b128 v[12:15], v102 offset:5120
    ds_read_b128 v[16:19], v102 offset:4864
    s_mov_b64 exec, -1
    v_exp_f32 v70, v70
    v_exp_f32 v71, v71
    v_exp_f32 v72, v72
    v_exp_f32 v73, v73
    s_waitcnt lgkmcnt(2)
    v_mfma_f32_32x32x16_bf16 v[52:67], v[8:11], v[4:7], v[36:51]
    ds_read_b128 v[8:11], v102 offset:6144
    v_exp_f32 v74, v74
    v_exp_f32 v75, v75
    v_exp_f32 v76, v76
    v_exp_f32 v77, v77
    v_smfmac_f32_32x32x32_bf16 v[84:99], v[20:23], v[68:75], v35
    v_exp_f32 v78, v78
    v_exp_f32 v79, v79
    v_exp_f32 v80, v80
    v_exp_f32 v81, v81
    s_sub_u32 s62, s62, 1
    s_cmp_lg_u32 s62, 0
    v_exp_f32 v82, v82
    v_exp_f32 v83, v83
    s_cbranch_scc1 A_LOOP
    s_branch A_SEGS
.p2align 6
A_LOOPX:
    s_setprio 3
    v_exp_f32 v52, v52
    v_exp_f32 v53, v53
    v_smfmac_f32_32x32x32_bf16 v[84:99], v[24:27], v[76:83], v35
    s_mov_b64 exec, s[58:59]
    ds_read_b128 v[20:23], v102 offset:7168
    ds_read_b128 v[24:27], v102 offset:6912
    s_mov_b64 exec, -1
    v_exp_f32 v54, v54
    v_exp_f32 v55, v55
    v_exp_f32 v56, v56
    v_exp_f32 v57, v57
    s_waitcnt lgkmcnt(2)
    v_mfma_f32_32x32x16_bf16 v[68:83], v[8:11], v[4:7], v[36:51]
    ds_read_b128 v[8:11], v102 offset:8192
    v_exp_f32 v58, v58
    v_exp_f32 v59, v59
    v_exp_f32 v60, v60
    v_exp_f32 v61, v61
    v_smfmac_f32_32x32x32_bf16 v[84:99], v[12:15], v[52:59], v35
    v_exp_f32 v62, v62
    v_exp_f32 v63, v63
    v_exp_f32 v64, v64
    v_exp_f32 v65, v65
    v_exp_f32 v66, v66
    v_exp_f32 v67, v67
    v_exp_f32 v68, v68
    v_exp_f32 v69, v69
    v_smfmac_f32_32x32x32_bf16 v[84:99], v[16:19], v[60:67], v35
    s_mov_b64 exec, s[58:59]
    ds_read_b128 v[12:15], v102 offset:9216
    ds_read_b128 v[16:19], v102 offset:8960
    s_mov_b64 exec, -1
    v_exp_f32 v70, v70
    v_exp_f32 v71, v71
    v_exp_f32 v72, v72
    v_exp_f32 v73, v73
    s_waitcnt lgkmcnt(2)
    v_mfma_f32_32x32x16_bf16 v[52:67], v[8:11], v[4:7], v[36:51]
    ds_read_b128 v[8:11], v102 offset:10240
    v_exp_f32 v74, v74
    v_exp_f32 v75, v75
    v_exp_f32 v76, v76
    v_exp_f32 v77, v77
    v_smfmac_f32_32x32x32_bf16 v[84:99], v[20:23], v[68:75], v35
    v_exp_f32 v78, v78
    v_exp_f32 v79, v79
    s_setprio 1
    v_exp_f32 v80, v80
    v_exp_f32 v81, v81
    v_add_u32 v102, 8192, v102
    v_exp_f32 v82, v82
    v_exp_f32 v83, v83
A_LOOPXM:
    s_setprio 3
    v_exp_f32 v52, v52
    v_exp_f32 v53, v53
    v_smfmac_f32_32x32x32_bf16 v[84:99], v[24:27], v[76:83], v35
    s_mov_b64 exec, s[58:59]
    ds_read_b128 v[20:23], v102 offset:3072
    ds_read_b128 v[24:27], v102 offset:2816
    s_mov_b64 exec, -1
    v_exp_f32 v54, v54
    v_exp_f32 v55, v55
    v_exp_f32 v56, v56
    v_exp_f32 v57, v57
    s_waitcnt lgkmcnt(2)
    v_mfma_f32_32x32x16_bf16 v[68:83], v[8:11], v[4:7], v[36:51]
    ds_read_b128 v[8:11], v102 offset:4096
    v_exp_f32 v58, v58
    v_exp_f32 v59, v59
    v_exp_f32 v60, v60
    v_exp_f32 v61, v61
    v_smfmac_f32_32x32x32_bf16 v[84:99], v[12:15], v[52:59], v35
    v_exp_f32 v62, v62
    v_exp_f32 v63, v63
    v_exp_f32 v64, v64
    v_exp_f32 v65, v65
    v_exp_f32 v66, v66
    v_exp_f32 v67, v67
    v_exp_f32 v68, v68
    v_exp_f32 v69, v69
    v_smfmac_f32_32x32x32_bf16 v[84:99], v[16:19], v[60:67], v35
    s_mov_b64 exec, s[58:59]
    ds_read_b128 v[12:15], v102 offset:5120
    ds_read_b128 v[16:19], v102 offset:4864
    s_mov_b64 exec, -1
    v_exp_f32 v70, v70
    v_exp_f32 v71, v71
    v_exp_f32 v72, v72
    v_exp_f32 v73, v73
    s_waitcnt lgkmcnt(2)
    v_mfma_f32_32x32x16_bf16 v[52:67], v[8:11], v[4:7], v[36:51]
    ds_read_b128 v[8:11], v102 offset:6144
    v_exp_f32 v74, v74
    v_exp_f32 v75, v75
    v_exp_f32 v76, v76
    v_exp_f32 v77, v77
    v_smfmac_f32_32x32x32_bf16 v[84:99], v[20:23], v[68:75], v35
    v_exp_f32 v78, v78
    v_exp_f32 v79, v79
    s_setprio 1
    v_exp_f32 v80, v80
    v_exp_f32 v81, v81
    s_sub_u32 s62, s62, 1
    s_cmp_lg_u32 s62, 0
    v_exp_f32 v82, v82
    v_exp_f32 v83, v83
    s_cbranch_scc1 A_LOOPX
A_SEGS:
WP935:
    s_cbranch_execz WP1099
    s_add_u32 s63, s63, 1
    s_cmp_eq_u32 s63, 6
    s_cbranch_scc1 A_SEG5
    s_cmp_eq_u32 s63, 1
    s_cbranch_scc0 A_SEG1
    s_mov_b32 s31, 0x40000
SP_6:
    ds_read_b32 v101, v3 offset:16
    s_sub_u32 s31, s31, 1
    s_waitcnt lgkmcnt(0)
    v_readfirstlane_b32 s30, v101
    s_cbranch_scc1 SP_6_X
    s_cmp_ge_u32 s30, 1
    s_cbranch_scc1 SP_6_X
    s_sleep 1
    s_branch SP_6
SP_6_X:
    s_mov_b32 s62, 4
    s_cmp_lt_u32 s28, 4
    s_cbranch_scc1 A_LOOPX
    s_branch A_LOOP
A_SEG1:
    s_cmp_eq_u32 s63, 2
    s_cbranch_scc0 A_SEG2
    s_mov_b32 s31, 0x40000
SP_7:
    ds_read_b32 v101, v3 offset:60
    s_sub_u32 s31, s31, 1
    s_waitcnt lgkmcnt(0)
    v_readfirstlane_b32 s30, v101
    s_cbranch_scc1 SP_7_X
    s_cmp_ge_u32 s30, 1
    s_cbranch_scc1 SP_7_X
    s_sleep 1
    s_branch SP_7
SP_7_X:
    s_mov_b32 s62, 4
    s_cmp_lt_u32 s28, 4
    s_cbranch_scc1 A_LOOPX
    s_branch A_LOOP
A_SEG2:
    s_cmp_eq_u32 s63, 3
    s_cbranch_scc0 A_SEG3
    s_mov_b32 s31, 0x40000
SP_8:
    ds_read_b32 v101, v3 offset:20
    s_sub_u32 s31, s31, 1
    s_waitcnt lgkmcnt(0)
    v_readfirstlane_b32 s30, v101
    s_cbranch_scc1 SP_8_X
    s_cmp_ge_u32 s30, 4
    s_cbranch_scc1 SP_8_X
    s_sleep 1
    s_branch SP_8
SP_8_X:
    s_mov_b32 s62, 2
    s_cmp_lt_u32 s28, 4
    s_cbranch_scc1 A_LOOPX
    s_branch A_LOOP
A_SEG3:
    s_cmp_eq_u32 s63, 4
    s_cbranch_scc0 A_SEG4
    s_setprio 1
    s_mov_b32 s62, 2
    v_add_u32 v102, 4096, v102
    s_branch A_LOOPM
A_SEG4:
    s_cmp_eq_u32 s63, 5
    s_cbranch_scc0 A_SEG5
    s_setprio 0
    s_mov_b32 s62, 1
    s_branch A_LOOP
A_SEG5:
    s_setprio 3
    v_smfmac_f32_32x32x32_bf16 v[84:99], v[24:27], v[76:83], v35
    s_waitcnt vmcnt(0) lgkmcnt(0)
    ds_read_b32 v103, v3 offset:52
    v_mov_b32 v56, 0xd800000
    v_mov_b32 v57, 0x7e000000
    v_lshlrev_b32 v68, 16, v120
    v_and_b32 v69, 0xffff0000, v120
    v_lshlrev_b32 v70, 16, v121
    v_and_b32 v71, 0xffff0000, v121
    v_lshlrev_b32 v72, 16, v122
    v_and_b32 v73, 0xffff0000, v122
    v_lshlrev_b32 v74, 16, v123
    v_and_b32 v75, 0xffff0000, v123
    s_nop 0
    v_rcp_f32 v100, v84
    v_maximum3_f32 v52, |v92|, |v93|, |v94|
    v_minimum3_f32 v53, |v92|, |v93|, |v94|
    v_maximum3_f32 v54, |v95|, |v96|, |v97|
    v_minimum3_f32 v55, |v95|, |v96|, |v97|
    v_maximum3_f32 v52, |v98|, |v99|, v52
    v_minimum3_f32 v53, |v98|, |v99|, v53
    v_maximum3_f32 v52, v84, v54, v52
    v_minimum3_f32 v53, v84, v55, v53
    v_cmp_lt_f32 s[64:65], v52, v57
    v_cmp_gt_f32 vcc, v53, v56
    v_mul_f32 v92, v92, v100
    v_mul_f32 v93, v93, v100
    v_mul_f32 v94, v94, v100
    v_mul_f32 v95, v95, v100
    v_mul_f32 v96, v96, v100
    v_mul_f32 v97, v97, v100
    v_mul_f32 v98, v98, v100
    v_mul_f32 v99, v99, v100
    s_and_b64 s[64:65], s[64:65], vcc
    s_waitcnt lgkmcnt(0)
    v_readfirstlane_b32 s30, v103
    v_cvt_pk_bf16_f32 v28, v92, v93
    v_cvt_pk_bf16_f32 v29, v94, v95
    v_cvt_pk_bf16_f32 v30, v96, v97
    v_cvt_pk_bf16_f32 v31, v98, v99
    s_cmp_eq_u64 s[64:65], -1
    s_cbranch_scc1 A_FIN
    s_cmp_eq_u32 s60, 64
    s_cbranch_scc1 A_FIN
    s_mov_b32 s60, 64
    s_mov_b32 s61, 0
    v_mov_b32 v102, v2
    v_mov_b32 v100, 0xff800000
    s_mov_b32 s62, 64
A_PRE:
    ds_read_b128 v[8:11], v102
    v_add_u32 v102, 2048, v102
    s_waitcnt lgkmcnt(0)
    v_mfma_f32_32x32x16_bf16 v[52:67], v[8:11], v[4:7], 0
    s_nop 12
    v_max3_f32 v100, v52, v53, v100
    v_max3_f32 v100, v54, v55, v100
    v_max3_f32 v100, v56, v57, v100
    v_max3_f32 v100, v58, v59, v100
    v_max3_f32 v100, v60, v61, v100
    v_max3_f32 v100, v62, v63, v100
    v_max3_f32 v100, v64, v65, v100
    v_max3_f32 v100, v66, v67, v100
    s_sub_u32 s62, s62, 1
    s_cmp_lg_u32 s62, 0
    s_cbranch_scc1 A_PRE
    v_mov_b64 v[84:85], 0
    v_mov_b64 v[86:87], 0
    v_mov_b64 v[88:89], 0
    v_mov_b64 v[90:91], 0
    v_mov_b64 v[92:93], 0
    v_mov_b64 v[94:95], 0
    v_mov_b64 v[96:97], 0
    v_and_b32 v12, 27, v1
    v_cmp_eq_u32 vcc, 0, v12
    v_mov_b32 v13, s54
    v_mov_b64 v[98:99], 0
    v_cndmask_b32 v12, 0, v13, vcc
    v_mov_b32 v13, v12
    v_mov_b64 v[14:15], v[12:13]
    v_mov_b64 v[16:17], v[12:13]
    v_mov_b64 v[18:19], v[12:13]
    v_mov_b64 v[20:21], v[12:13]
    v_mov_b64 v[22:23], v[12:13]
    v_mov_b64 v[24:25], v[12:13]
    v_mov_b64 v[26:27], v[12:13]
    v_mov_b32 v102, v2
    ds_read_b128 v[8:11], v102
    s_branch A_GO
A_FIN:
WP1099:
    s_cbranch_execz WRET3
    s_cmp_eq_u32 s30, 1
    s_cbranch_scc1 A_OLOC
    buffer_store_dwordx4 v[28:31], v2, s[36:39], s56 offen sc1
    s_branch A_ODONE
A_OLOC:
    buffer_store_dwordx4 v[28:31], v2, s[36:39], s56 offen
A_ODONE:
    s_cmp_lt_u32 s28, 4
    s_cselect_b32 s30, 17, 1
    v_mov_b32 v6, s30
    s_mov_b64 exec, 1
    ds_add_u32 v3, v6 offset:44
    s_mov_b64 exec, -1
    s_mul_i32 s50, s28, 2176
    v_lshrrev_b32 v4, 3, v1
    v_mul_u32_u24 v4, 272, v4
    v_and_b32 v5, 7, v1
    v_lshl_add_u32 v4, v5, 5, v4
    v_add_u32 v4, s50, v4
    s_barrier
    ds_read_b128 v[16:19], v4 offset:0
    ds_read_b128 v[20:23], v4 offset:16
    ds_read_b128 v[24:27], v4 offset:17408
    ds_read_b128 v[28:31], v4 offset:17424
    ds_read_b128 v[32:35], v4 offset:34816
    ds_read_b128 v[36:39], v4 offset:34832
    ds_read_b128 v[40:43], v4 offset:52224
    ds_read_b128 v[44:47], v4 offset:52240
    s_waitcnt lgkmcnt(6)
    v_pk_add_f32 v[68:69], v[68:69], v[16:17]
    v_pk_add_f32 v[70:71], v[70:71], v[18:19]
    v_pk_add_f32 v[72:73], v[72:73], v[20:21]
    v_pk_add_f32 v[74:75], v[74:75], v[22:23]
    s_waitcnt lgkmcnt(4)
    v_pk_add_f32 v[68:69], v[68:69], v[24:25]
    v_pk_add_f32 v[70:71], v[70:71], v[26:27]
    v_pk_add_f32 v[72:73], v[72:73], v[28:29]
    v_pk_add_f32 v[74:75], v[74:75], v[30:31]
    s_waitcnt lgkmcnt(2)
    v_pk_add_f32 v[68:69], v[68:69], v[32:33]
    v_pk_add_f32 v[70:71], v[70:71], v[34:35]
    v_pk_add_f32 v[72:73], v[72:73], v[36:37]
    v_pk_add_f32 v[74:75], v[74:75], v[38:39]
    s_waitcnt lgkmcnt(0)
    v_pk_add_f32 v[68:69], v[68:69], v[40:41]
    v_pk_add_f32 v[70:71], v[70:71], v[42:43]
    v_pk_add_f32 v[72:73], v[72:73], v[44:45]
    v_pk_add_f32 v[74:75], v[74:75], v[46:47]
    v_cvt_pk_bf16_f32 v120, v68, v69
    v_cvt_pk_bf16_f32 v121, v70, v71
    v_cvt_pk_bf16_f32 v122, v72, v73
    v_cvt_pk_bf16_f32 v123, v74, v75
    buffer_store_dwordx4 v[120:123], v124, s[44:47], s48 offen
    s_endpgm
G_START:
WP1154:
    s_cbranch_execz WRET1
    s_setprio 3
    s_sub_u32 s62, s28, 8
    s_cmp_eq_u32 s62, 3
    s_cbranch_scc1 G3_START
    s_mov_b32 s40, s16
    s_mov_b32 s41, s17
    s_mov_b32 s42, 0x158000
    s_mov_b32 s43, 0x00020000
    s_mov_b32 s48, s12
    s_mov_b32 s49, s13
    s_mov_b32 s50, 0x80000
    s_mov_b32 s51, 0x00020000
    s_lshl_b32 s52, s62, 5
    s_add_u32 s52, s52, s26
    s_cmp_lt_u32 s52, 86
    s_cselect_b32 s44, s18, s12
    s_cselect_b32 s45, s19, s13
    s_mov_b32 s46, 0x80000
    s_cselect_b32 s46, 0x158000, s46
    s_mov_b32 s47, 0x00020000
    s_cselect_b32 s53, 0, 86
    s_sub_u32 s53, s52, s53
    s_lshl_b32 s53, s53, 14
    s_lshl_b32 s54, s27, 7
    s_add_u32 s53, s53, s54
    s_mul_i32 s55, s27, 236
    s_add_u32 s56, s55, s52
    s_lshl_b32 s56, s56, 10
    s_add_u32 s56, s56, 0x900000
    s_add_u32 s57, s26, 10
    s_lshl_b32 s57, s57, 14
    s_add_u32 s57, s57, s54
    s_add_u32 s58, s55, s26
    s_lshl_b32 s58, s58, 10
    s_add_u32 s58, s58, 0x918000
    s_cmp_lt_u32 s26, 22
    s_cselect_b32 s59, s62, 0
    s_cmp_eq_u32 s59, 2
    s_cselect_b32 s57, s57, 0x7f000000
    s_cselect_b32 s58, s58, 0x7f000000
    s_mul_i32 s59, s27, 3
    s_lshl_b32 s60, s27, 1
    s_add_u32 s60, s60, 6
    s_cmp_lt_u32 s27, 6
    s_cselect_b32 s59, s59, s60
    s_cselect_b32 s61, 0, s62
    s_add_u32 s59, s59, s62
    s_lshl_b32 s60, s59, 7
    s_cmp_eq_u32 s61, 2
    s_cselect_b32 s60, 0x7f000000, s60
    s_mul_i32 s63, s62, 10240
    s_add_u32 s63, s63, 131072
    v_lshrrev_b32 v4, 3, v1
    v_and_b32 v5, 2, v4
    v_lshlrev_b32 v5, 1, v5
    v_and_b32 v6, 7, v1
    v_xor_b32 v5, v5, v6
    v_lshlrev_b32 v5, 4, v5
    v_lshl_add_u32 v102, v4, 10, v5
    v_add_u32 v103, 7168, v102
    v_mul_u32_u24 v100, 2752, v4
    v_add_u32 v100, v100, v5
    v_add_u32 v101, 20992, v100
    s_barrier
    s_mov_b32 s64, s6
    s_mov_b32 s65, s7
    s_mov_b32 s66, 0x80000
    s_mov_b32 s67, 0x00020000
    v_and_b32 v7, 2, v4
    s_and_b32 s30, s62, 1
    v_or_b32 v7, s30, v7
    v_lshlrev_b32 v7, 1, v7
    v_xor_b32 v7, v7, v6
    v_lshlrev_b32 v7, 4, v7
    v_lshl_add_u32 v7, v4, 10, v7
    v_xor_b32 v8, 32, v7
    s_lshl_b32 s30, s62, 13
    s_add_u32 s30, s30, s54
    s_lshl_b32 s31, s62, 10
    s_lshl_b32 s69, s26, 14
    s_lshl_b32 s68, s26, 11
    s_xor_b32 m0, s31, s68
    s_add_u32 s31, s31, 3072
    s_xor_b32 s3, s30, s69
    buffer_load_dwordx4 v7, s[64:67], s3 offen lds
    s_add_u32 s30, s30, 24576
    s_xor_b32 m0, s31, s68
    s_add_u32 s31, s31, 3072
    s_xor_b32 s3, s30, s69
    buffer_load_dwordx4 v8, s[64:67], s3 offen lds
    s_add_u32 s30, s30, 24576
    s_xor_b32 m0, s31, s68
    s_add_u32 s31, s31, 3072
    s_xor_b32 s3, s30, s69
    buffer_load_dwordx4 v7, s[64:67], s3 offen lds
    s_add_u32 s30, s30, 24576
    s_xor_b32 m0, s31, s68
    s_add_u32 s31, s31, 3072
    s_xor_b32 s3, s30, s69
    buffer_load_dwordx4 v8, s[64:67], s3 offen lds
    s_add_u32 s30, s30, 24576
    s_xor_b32 m0, s31, s68
    s_add_u32 s31, s31, 3072
    s_xor_b32 s3, s30, s69
    buffer_load_dwordx4 v7, s[64:67], s3 offen lds
    s_add_u32 s30, s30, 24576
    s_xor_b32 m0, s31, s68
    s_add_u32 s31, s31, 3072
    s_xor_b32 s3, s30, s69
    buffer_load_dwordx4 v8, s[64:67], s3 offen lds
    s_add_u32 s30, s30, 24576
    s_xor_b32 m0, s31, s68
    s_add_u32 s31, s31, 3072
    s_xor_b32 s3, s30, s69
    buffer_load_dwordx4 v7, s[64:67], s3 offen lds
    s_add_u32 s30, s30, 24576
    s_xor_b32 m0, s31, s68
    s_add_u32 s31, s31, 3072
    s_xor_b32 s3, s30, s69
    buffer_load_dwordx4 v8, s[64:67], s3 offen lds
    s_add_u32 s30, s30, 24576
    s_xor_b32 m0, s31, s68
    s_add_u32 s31, s31, 3072
    s_xor_b32 s3, s30, s69
    buffer_load_dwordx4 v7, s[64:67], s3 offen lds
    s_add_u32 s30, s30, 24576
    s_xor_b32 m0, s31, s68
    s_add_u32 s31, s31, 3072
    s_xor_b32 s3, s30, s69
    buffer_load_dwordx4 v8, s[64:67], s3 offen lds
    s_add_u32 s30, s30, 24576
    s_xor_b32 m0, s31, s68
    s_add_u32 s31, s31, 3072
    s_xor_b32 s3, s30, s69
    buffer_load_dwordx4 v7, s[64:67], s3 offen lds
WP1289:
    s_cbranch_execz WRET1
    s_add_u32 s30, s30, 24576
    s_xor_b32 m0, s31, s68
    s_add_u32 s31, s31, 3072
    s_xor_b32 s3, s30, s69
    buffer_load_dwordx4 v8, s[64:67], s3 offen lds
    s_add_u32 s30, s30, 24576
    s_xor_b32 m0, s31, s68
    s_add_u32 s31, s31, 3072
    s_xor_b32 s3, s30, s69
    buffer_load_dwordx4 v7, s[64:67], s3 offen lds
    s_add_u32 s30, s30, 24576
    s_xor_b32 m0, s31, s68
    s_add_u32 s31, s31, 3072
    s_xor_b32 s3, s30, s69
    buffer_load_dwordx4 v8, s[64:67], s3 offen lds
    s_add_u32 s30, s30, 24576
    s_xor_b32 m0, s31, s68
    s_add_u32 s31, s31, 3072
    s_xor_b32 s3, s30, s69
    buffer_load_dwordx4 v7, s[64:67], s3 offen lds
    s_add_u32 s30, s30, 24576
    s_xor_b32 m0, s31, s68
    s_add_u32 s31, s31, 3072
    s_xor_b32 s3, s30, s69
    buffer_load_dwordx4 v8, s[64:67], s3 offen lds
    s_add_u32 s30, s30, 24576
    s_xor_b32 m0, s31, s68
    s_add_u32 s31, s31, 3072
    s_xor_b32 s3, s30, s69
    buffer_load_dwordx4 v7, s[64:67], s3 offen lds
    s_add_u32 s30, s30, 24576
    s_xor_b32 m0, s31, s68
    s_add_u32 s31, s31, 3072
    s_xor_b32 s3, s30, s69
    buffer_load_dwordx4 v8, s[64:67], s3 offen lds
    s_add_u32 s30, s30, 24576
    s_xor_b32 m0, s31, s68
    s_add_u32 s31, s31, 3072
    s_xor_b32 s3, s30, s69
    buffer_load_dwordx4 v7, s[64:67], s3 offen lds
    s_add_u32 s30, s30, 24576
    s_xor_b32 m0, s31, s68
    s_add_u32 s31, s31, 3072
    s_xor_b32 s3, s30, s69
    buffer_load_dwordx4 v8, s[64:67], s3 offen lds
    s_add_u32 s30, s30, 24576
    s_xor_b32 m0, s31, s68
    s_add_u32 s31, s31, 3072
    s_xor_b32 s3, s30, s69
    buffer_load_dwordx4 v7, s[64:67], s3 offen lds
    s_add_u32 s30, s30, 24576
    s_cmp_eq_u32 s62, 0
    s_cbranch_scc0 G_WQD
    s_xor_b32 m0, s31, s68
    s_add_u32 s31, s31, 3072
    s_xor_b32 s3, s30, s69
    buffer_load_dwordx4 v8, s[64:67], s3 offen lds
    s_add_u32 s30, s30, 24576
G_WQD:
    s_mov_b64 exec, 0
    s_cmp_eq_u32 s28, 8
    s_cbranch_scc1 WP1536
    s_cmp_eq_u32 s28, 9
    s_cbranch_scc1 WP1641
    s_cmp_eq_u32 s28, 10
    s_cbranch_scc1 WP1744
WRET2:
    s_mov_b64 exec, -1
    s_waitcnt vmcnt(0)
    v_mov_b32 v9, 1
    s_mov_b64 exec, 1
    ds_add_u32 v3, v9 offset:576
    s_mov_b64 exec, -1
    s_mov_b32 s31, 0x40000
SP_9:
    ds_read_b32 v9, v3 offset:0
    s_sub_u32 s31, s31, 1
    s_waitcnt lgkmcnt(0)
    v_readfirstlane_b32 s30, v9
    s_cbranch_scc1 SP_9_X
    s_cmp_ge_u32 s30, 1
    s_cbranch_scc1 SP_9_X
    s_sleep 1
    s_branch SP_9
SP_9_X:
    s_mov_b32 s31, 0x40000
SP_10:
    ds_read_b32 v9, v3 offset:4
    s_sub_u32 s31, s31, 1
    s_waitcnt lgkmcnt(0)
    v_readfirstlane_b32 s30, v9
    s_cbranch_scc1 SP_10_X
    s_cmp_ge_u32 s30, 8
    s_cbranch_scc1 SP_10_X
    s_sleep 2
    s_branch SP_10
SP_10_X:
    s_add_u32 m0, s63, 0
    s_nop 0
    buffer_load_dwordx4 v102, s[44:47], s53 offen lds
    buffer_load_dwordx4 v103, s[44:47], s53 offen offset:1024 lds
    s_add_u32 m0, s63, 2048
    s_nop 0
    buffer_load_dwordx4 v102, s[48:51], s57 offen lds
    buffer_load_dwordx4 v103, s[48:51], s57 offen offset:1024 lds
    s_add_u32 m0, s63, 4096
    s_add_u32 s3, s60, 0
    buffer_load_dwordx4 v100, s[40:43], s3 offen lds
    buffer_load_dwordx4 v101, s[40:43], s3 offen offset:1024 lds
    s_add_u32 m0, s63, 6144
    s_add_u32 s3, s60, 44032
    buffer_load_dwordx4 v100, s[40:43], s3 offen lds
    buffer_load_dwordx4 v101, s[40:43], s3 offen offset:1024 lds
    s_add_u32 m0, s63, 8192
    s_add_u32 s3, s60, 88064
    buffer_load_dwordx4 v100, s[40:43], s3 offen lds
    buffer_load_dwordx4 v101, s[40:43], s3 offen offset:1024 lds
    v_lshrrev_b32 v4, 5, v1
    v_bfe_u32 v5, v1, 2, 2
    v_bfe_u32 v6, v1, 4, 1
    v_and_b32 v7, 2, v5
    v_or_b32 v6, v6, v7
    v_lshlrev_b32 v6, 5, v6
    v_and_b32 v7, 3, v1
    v_lshl_add_u32 v6, v7, 3, v6
    v_lshl_add_u32 v6, v5, 7, v6
    v_add_u32 v6, s63, v6
    v_lshl_add_u32 v104, v4, 10, v6
    v_xor_b32 v105, 64, v104
    v_lshl_add_u32 v106, v4, 9, v6
    v_xor_b32 v107, 64, v106
    v_and_b32 v5, 31, v1
    v_or_b32 v6, 0, v4
    v_xor_b32 v6, v6, v5
    v_lshlrev_b32 v6, 4, v6
    v_lshl_add_u32 v6, v4, 9, v6
    v_add_u32 v108, 65536, v6
    v_or_b32 v6, 2, v4
    v_xor_b32 v6, v6, v5
    v_lshlrev_b32 v6, 4, v6
    v_lshl_add_u32 v6, v4, 9, v6
WP1422:
    s_cbranch_execz WRET1
    v_add_u32 v109, 65536, v6
    v_or_b32 v6, 4, v4
    v_xor_b32 v6, v6, v5
    v_lshlrev_b32 v6, 4, v6
    v_lshl_add_u32 v6, v4, 9, v6
    v_add_u32 v110, 65536, v6
    v_or_b32 v6, 6, v4
    v_xor_b32 v6, v6, v5
    v_lshlrev_b32 v6, 4, v6
    v_lshl_add_u32 v6, v4, 9, v6
    v_add_u32 v111, 65536, v6
    s_waitcnt vmcnt(8)
    ds_read_b64_tr_b16 v[112:113], v106 offset:0
    ds_read_b64_tr_b16 v[114:115], v106 offset:1024
    ds_read_b64_tr_b16 v[116:117], v107 offset:0
    ds_read_b64_tr_b16 v[118:119], v107 offset:1024
    s_waitcnt lgkmcnt(0)
    buffer_store_dwordx4 v[112:115], v2, s[36:39], s56 offen sc1
    s_add_u32 s56, s56, 120832
    buffer_store_dwordx4 v[116:119], v2, s[36:39], s56 offen sc1
    s_add_u32 m0, s63, 0
    s_add_u32 s3, s60, 132096
    buffer_load_dwordx4 v100, s[40:43], s3 offen lds
    buffer_load_dwordx4 v101, s[40:43], s3 offen offset:1024 lds
    s_waitcnt vmcnt(10)
    ds_read_b64_tr_b16 v[120:121], v106 offset:2048
    ds_read_b64_tr_b16 v[122:123], v106 offset:3072
    ds_read_b64_tr_b16 v[124:125], v107 offset:2048
    ds_read_b64_tr_b16 v[126:127], v107 offset:3072
    s_waitcnt lgkmcnt(0)
    buffer_store_dwordx4 v[120:123], v2, s[36:39], s58 offen sc1
    s_add_u32 s58, s58, 120832
    buffer_store_dwordx4 v[124:127], v2, s[36:39], s58 offen sc1
    s_add_u32 m0, s63, 2048
    s_add_u32 s3, s60, 176128
    buffer_load_dwordx4 v100, s[40:43], s3 offen lds
    buffer_load_dwordx4 v101, s[40:43], s3 offen offset:1024 lds
    s_mul_i32 s52, s26, 236
    s_lshl_b32 s53, s59, 2
    s_add_u32 s52, s52, s53
    s_lshl_b32 s52, s52, 10
    s_add_u32 s52, s52, 0x100000
    s_add_u32 s53, s52, 120832
    s_cmp_eq_u32 s59, 21
    s_cselect_b32 s54, 0x7f000000, s52
    s_cselect_b32 s55, 0x7f000000, s53
    s_cmp_eq_u32 s61, 2
    s_cbranch_scc1 G_F1IDLE
    s_mov_b32 s31, 0x40000
SP_11:
    ds_read_b32 v4, v3 offset:4
    s_sub_u32 s31, s31, 1
    s_waitcnt lgkmcnt(0)
    v_readfirstlane_b32 s30, v4
    s_cbranch_scc1 SP_11_X
    s_cmp_ge_u32 s30, 8
    s_cbranch_scc1 SP_11_X
    s_sleep 2
    s_branch SP_11
SP_11_X:
    s_setprio 0
    s_waitcnt vmcnt(12)
    ds_read_b64_tr_b16 v[68:69], v104 offset:4096
    ds_read_b64_tr_b16 v[70:71], v104 offset:4608
    ds_read_b64_tr_b16 v[72:73], v105 offset:4096
    ds_read_b64_tr_b16 v[74:75], v105 offset:4608
    ds_read_b128 v[84:87], v108 offset:0
    ds_read_b128 v[88:91], v108 offset:16384
    s_waitcnt lgkmcnt(0)
    v_mfma_f32_32x32x16_bf16 v[4:19], v[68:71], v[84:87], 0
    s_add_u32 m0, s63, 4096
    s_add_u32 s3, s60, 220160
    buffer_load_dwordx4 v100, s[40:43], s3 offen lds
    buffer_load_dwordx4 v101, s[40:43], s3 offen offset:1024 lds
    v_mfma_f32_32x32x16_bf16 v[20:35], v[68:71], v[88:91], 0
    s_waitcnt vmcnt(12)
    ds_read_b64_tr_b16 v[76:77], v104 offset:6144
    ds_read_b64_tr_b16 v[78:79], v104 offset:6656
    ds_read_b64_tr_b16 v[80:81], v105 offset:6144
    ds_read_b64_tr_b16 v[82:83], v105 offset:6656
    ds_read_b128 v[92:95], v109 offset:1024
    ds_read_b128 v[96:99], v109 offset:17408
    v_mfma_f32_32x32x16_bf16 v[36:51], v[72:75], v[84:87], 0
    v_mfma_f32_32x32x16_bf16 v[52:67], v[72:75], v[88:91], 0
    s_waitcnt lgkmcnt(0)
    v_mfma_f32_32x32x16_bf16 v[4:19], v[76:79], v[92:95], v[4:19]
    s_add_u32 m0, s63, 6144
    s_add_u32 s3, s60, 264192
    buffer_load_dwordx4 v100, s[40:43], s3 offen lds
    buffer_load_dwordx4 v101, s[40:43], s3 offen offset:1024 lds
    v_mfma_f32_32x32x16_bf16 v[20:35], v[76:79], v[96:99], v[20:35]
    s_waitcnt vmcnt(12)
    ds_read_b64_tr_b16 v[68:69], v104 offset:8192
    ds_read_b64_tr_b16 v[70:71], v104 offset:8704
    ds_read_b64_tr_b16 v[72:73], v105 offset:8192
    ds_read_b64_tr_b16 v[74:75], v105 offset:8704
    ds_read_b128 v[84:87], v110 offset:2048
    ds_read_b128 v[88:91], v110 offset:18432
    v_mfma_f32_32x32x16_bf16 v[36:51], v[80:83], v[92:95], v[36:51]
    v_mfma_f32_32x32x16_bf16 v[52:67], v[80:83], v[96:99], v[52:67]
    s_waitcnt lgkmcnt(0)
    v_mfma_f32_32x32x16_bf16 v[4:19], v[68:71], v[84:87], v[4:19]
    s_add_u32 m0, s63, 8192
    s_add_u32 s3, s60, 308224
    buffer_load_dwordx4 v100, s[40:43], s3 offen lds
    buffer_load_dwordx4 v101, s[40:43], s3 offen offset:1024 lds
    v_mfma_f32_32x32x16_bf16 v[20:35], v[68:71], v[88:91], v[20:35]
    s_waitcnt vmcnt(10)
    ds_read_b64_tr_b16 v[76:77], v104 offset:0
    ds_read_b64_tr_b16 v[78:79], v104 offset:512
    ds_read_b64_tr_b16 v[80:81], v105 offset:0
    ds_read_b64_tr_b16 v[82:83], v105 offset:512
    ds_read_b128 v[92:95], v111 offset:3072
    ds_read_b128 v[96:99], v111 offset:19456
WP1536:
    s_cbranch_execz WP1848
    v_mfma_f32_32x32x16_bf16 v[36:51], v[72:75], v[84:87], v[36:51]
    v_mfma_f32_32x32x16_bf16 v[52:67], v[72:75], v[88:91], v[52:67]
    s_waitcnt lgkmcnt(0)
    v_mfma_f32_32x32x16_bf16 v[4:19], v[76:79], v[92:95], v[4:19]
    s_add_u32 m0, s63, 0
    s_add_u32 s3, s60, 352256
    buffer_load_dwordx4 v100, s[40:43], s3 offen lds
    buffer_load_dwordx4 v101, s[40:43], s3 offen offset:1024 lds
    v_mfma_f32_32x32x16_bf16 v[20:35], v[76:79], v[96:99], v[20:35]
    s_waitcnt vmcnt(8)
    ds_read_b64_tr_b16 v[68:69], v104 offset:2048
    ds_read_b64_tr_b16 v[70:71], v104 offset:2560
    ds_read_b64_tr_b16 v[72:73], v105 offset:2048
    ds_read_b64_tr_b16 v[74:75], v105 offset:2560
    ds_read_b128 v[84:87], v108 offset:4096
    ds_read_b128 v[88:91], v108 offset:20480
    v_mov_b32 v0, 1
    s_mov_b64 exec, 1
    ds_add_u32 v3, v0 offset:596
    s_mov_b64 exec, -1
    v_mfma_f32_32x32x16_bf16 v[36:51], v[80:83], v[92:95], v[36:51]
    v_mfma_f32_32x32x16_bf16 v[52:67], v[80:83], v[96:99], v[52:67]
    s_waitcnt lgkmcnt(1)
    v_mfma_f32_32x32x16_bf16 v[4:19], v[68:71], v[84:87], v[4:19]
    s_add_u32 m0, s63, 2048
    s_add_u32 s3, s60, 396288
    buffer_load_dwordx4 v100, s[40:43], s3 offen lds
    buffer_load_dwordx4 v101, s[40:43], s3 offen offset:1024 lds
    v_mfma_f32_32x32x16_bf16 v[20:35], v[68:71], v[88:91], v[20:35]
    s_waitcnt vmcnt(8)
    ds_read_b64_tr_b16 v[76:77], v104 offset:4096
    ds_read_b64_tr_b16 v[78:79], v104 offset:4608
    ds_read_b64_tr_b16 v[80:81], v105 offset:4096
    ds_read_b64_tr_b16 v[82:83], v105 offset:4608
    ds_read_b128 v[92:95], v109 offset:5120
    ds_read_b128 v[96:99], v109 offset:21504
    v_mfma_f32_32x32x16_bf16 v[36:51], v[72:75], v[84:87], v[36:51]
    v_mfma_f32_32x32x16_bf16 v[52:67], v[72:75], v[88:91], v[52:67]
    s_waitcnt lgkmcnt(0)
    v_mfma_f32_32x32x16_bf16 v[4:19], v[76:79], v[92:95], v[4:19]
    s_add_u32 m0, s63, 4096
    s_add_u32 s3, s60, 440320
    buffer_load_dwordx4 v100, s[40:43], s3 offen lds
    buffer_load_dwordx4 v101, s[40:43], s3 offen offset:1024 lds
    v_mfma_f32_32x32x16_bf16 v[20:35], v[76:79], v[96:99], v[20:35]
    s_waitcnt vmcnt(8)
    ds_read_b64_tr_b16 v[68:69], v104 offset:6144
    ds_read_b64_tr_b16 v[70:71], v104 offset:6656
    ds_read_b64_tr_b16 v[72:73], v105 offset:6144
    ds_read_b64_tr_b16 v[74:75], v105 offset:6656
    ds_read_b128 v[84:87], v110 offset:6144
    ds_read_b128 v[88:91], v110 offset:22528
    v_mfma_f32_32x32x16_bf16 v[36:51], v[80:83], v[92:95], v[36:51]
    v_mfma_f32_32x32x16_bf16 v[52:67], v[80:83], v[96:99], v[52:67]
    s_waitcnt lgkmcnt(0)
    v_mfma_f32_32x32x16_bf16 v[4:19], v[68:71], v[84:87], v[4:19]
    s_add_u32 m0, s63, 6144
    s_add_u32 s3, s60, 484352
    buffer_load_dwordx4 v100, s[40:43], s3 offen lds
    buffer_load_dwordx4 v101, s[40:43], s3 offen offset:1024 lds
    v_mfma_f32_32x32x16_bf16 v[20:35], v[68:71], v[88:91], v[20:35]
    s_waitcnt vmcnt(8)
    ds_read_b64_tr_b16 v[76:77], v104 offset:8192
    ds_read_b64_tr_b16 v[78:79], v104 offset:8704
    ds_read_b64_tr_b16 v[80:81], v105 offset:8192
    ds_read_b64_tr_b16 v[82:83], v105 offset:8704
    ds_read_b128 v[92:95], v111 offset:7168
    ds_read_b128 v[96:99], v111 offset:23552
    v_mfma_f32_32x32x16_bf16 v[36:51], v[72:75], v[84:87], v[36:51]
    v_mfma_f32_32x32x16_bf16 v[52:67], v[72:75], v[88:91], v[52:67]
    s_waitcnt lgkmcnt(0)
    v_mfma_f32_32x32x16_bf16 v[4:19], v[76:79], v[92:95], v[4:19]
    s_add_u32 m0, s63, 8192
    s_add_u32 s3, s60, 528384
    buffer_load_dwordx4 v100, s[40:43], s3 offen lds
    buffer_load_dwordx4 v101, s[40:43], s3 offen offset:1024 lds
    v_mfma_f32_32x32x16_bf16 v[20:35], v[76:79], v[96:99], v[20:35]
    s_waitcnt vmcnt(8)
    ds_read_b64_tr_b16 v[68:69], v104 offset:0
    ds_read_b64_tr_b16 v[70:71], v104 offset:512
    ds_read_b64_tr_b16 v[72:73], v105 offset:0
    ds_read_b64_tr_b16 v[74:75], v105 offset:512
    ds_read_b128 v[84:87], v108 offset:8192
    ds_read_b128 v[88:91], v108 offset:24576
    v_mfma_f32_32x32x16_bf16 v[36:51], v[80:83], v[92:95], v[36:51]
    v_mfma_f32_32x32x16_bf16 v[52:67], v[80:83], v[96:99], v[52:67]
    s_waitcnt lgkmcnt(0)
    v_mfma_f32_32x32x16_bf16 v[4:19], v[68:71], v[84:87], v[4:19]
    s_add_u32 m0, s63, 0
    s_add_u32 s3, s60, 572416
    buffer_load_dwordx4 v100, s[40:43], s3 offen lds
    buffer_load_dwordx4 v101, s[40:43], s3 offen offset:1024 lds
    v_mfma_f32_32x32x16_bf16 v[20:35], v[68:71], v[88:91], v[20:35]
    s_waitcnt vmcnt(8)
    ds_read_b64_tr_b16 v[76:77], v104 offset:2048
    ds_read_b64_tr_b16 v[78:79], v104 offset:2560
    ds_read_b64_tr_b16 v[80:81], v105 offset:2048
    ds_read_b64_tr_b16 v[82:83], v105 offset:2560
    ds_read_b128 v[92:95], v109 offset:9216
    ds_read_b128 v[96:99], v109 offset:25600
    v_mfma_f32_32x32x16_bf16 v[36:51], v[72:75], v[84:87], v[36:51]
    v_mfma_f32_32x32x16_bf16 v[52:67], v[72:75], v[88:91], v[52:67]
    s_waitcnt lgkmcnt(0)
    v_mfma_f32_32x32x16_bf16 v[4:19], v[76:79], v[92:95], v[4:19]
    s_add_u32 m0, s63, 2048
WP1641:
    s_cbranch_execz WP1951
    s_add_u32 s3, s60, 616448
    buffer_load_dwordx4 v100, s[40:43], s3 offen lds
    buffer_load_dwordx4 v101, s[40:43], s3 offen offset:1024 lds
    v_mfma_f32_32x32x16_bf16 v[20:35], v[76:79], v[96:99], v[20:35]
    s_waitcnt vmcnt(8)
    ds_read_b64_tr_b16 v[68:69], v104 offset:4096
    ds_read_b64_tr_b16 v[70:71], v104 offset:4608
    ds_read_b64_tr_b16 v[72:73], v105 offset:4096
    ds_read_b64_tr_b16 v[74:75], v105 offset:4608
    ds_read_b128 v[84:87], v110 offset:10240
    ds_read_b128 v[88:91], v110 offset:26624
    v_mfma_f32_32x32x16_bf16 v[36:51], v[80:83], v[92:95], v[36:51]
    v_mfma_f32_32x32x16_bf16 v[52:67], v[80:83], v[96:99], v[52:67]
    s_waitcnt lgkmcnt(0)
    v_mfma_f32_32x32x16_bf16 v[4:19], v[68:71], v[84:87], v[4:19]
    s_add_u32 m0, s63, 4096
    s_add_u32 s3, s60, 660480
    buffer_load_dwordx4 v100, s[40:43], s3 offen lds
    buffer_load_dwordx4 v101, s[40:43], s3 offen offset:1024 lds
    v_mfma_f32_32x32x16_bf16 v[20:35], v[68:71], v[88:91], v[20:35]
    s_waitcnt vmcnt(8)
    ds_read_b64_tr_b16 v[76:77], v104 offset:6144
    ds_read_b64_tr_b16 v[78:79], v104 offset:6656
    ds_read_b64_tr_b16 v[80:81], v105 offset:6144
    ds_read_b64_tr_b16 v[82:83], v105 offset:6656
    ds_read_b128 v[92:95], v111 offset:11264
    ds_read_b128 v[96:99], v111 offset:27648
    v_mfma_f32_32x32x16_bf16 v[36:51], v[72:75], v[84:87], v[36:51]
    v_mfma_f32_32x32x16_bf16 v[52:67], v[72:75], v[88:91], v[52:67]
    s_waitcnt lgkmcnt(0)
    v_mfma_f32_32x32x16_bf16 v[4:19], v[76:79], v[92:95], v[4:19]
    s_add_u32 m0, s63, 6144
    s_add_u32 s3, s60, 704512
    buffer_load_dwordx4 v100, s[40:43], s3 offen lds
    buffer_load_dwordx4 v101, s[40:43], s3 offen offset:1024 lds
    v_mfma_f32_32x32x16_bf16 v[20:35], v[76:79], v[96:99], v[20:35]
    s_waitcnt vmcnt(8)
    ds_read_b64_tr_b16 v[68:69], v104 offset:8192
    ds_read_b64_tr_b16 v[70:71], v104 offset:8704
    ds_read_b64_tr_b16 v[72:73], v105 offset:8192
    ds_read_b64_tr_b16 v[74:75], v105 offset:8704
    ds_read_b128 v[84:87], v108 offset:12288
    ds_read_b128 v[88:91], v108 offset:28672
    v_mfma_f32_32x32x16_bf16 v[36:51], v[80:83], v[92:95], v[36:51]
    v_mfma_f32_32x32x16_bf16 v[52:67], v[80:83], v[96:99], v[52:67]
    s_waitcnt lgkmcnt(0)
    v_mfma_f32_32x32x16_bf16 v[4:19], v[68:71], v[84:87], v[4:19]
    s_add_u32 m0, s63, 8192
    s_add_u32 s3, s60, 748544
    buffer_load_dwordx4 v100, s[40:43], s3 offen lds
    buffer_load_dwordx4 v101, s[40:43], s3 offen offset:1024 lds
    v_mfma_f32_32x32x16_bf16 v[20:35], v[68:71], v[88:91], v[20:35]
    s_waitcnt vmcnt(8)
    ds_read_b64_tr_b16 v[76:77], v104 offset:0
    ds_read_b64_tr_b16 v[78:79], v104 offset:512
    ds_read_b64_tr_b16 v[80:81], v105 offset:0
    ds_read_b64_tr_b16 v[82:83], v105 offset:512
    ds_read_b128 v[92:95], v109 offset:13312
    ds_read_b128 v[96:99], v109 offset:29696
    v_mfma_f32_32x32x16_bf16 v[36:51], v[72:75], v[84:87], v[36:51]
    v_mfma_f32_32x32x16_bf16 v[52:67], v[72:75], v[88:91], v[52:67]
    s_waitcnt lgkmcnt(0)
    v_mfma_f32_32x32x16_bf16 v[4:19], v[76:79], v[92:95], v[4:19]
    s_add_u32 m0, s63, 0
    s_add_u32 s3, s60, 792576
    buffer_load_dwordx4 v100, s[40:43], s3 offen lds
    buffer_load_dwordx4 v101, s[40:43], s3 offen offset:1024 lds
    v_mfma_f32_32x32x16_bf16 v[20:35], v[76:79], v[96:99], v[20:35]
    s_waitcnt vmcnt(8)
    ds_read_b64_tr_b16 v[68:69], v104 offset:2048
    ds_read_b64_tr_b16 v[70:71], v104 offset:2560
    ds_read_b64_tr_b16 v[72:73], v105 offset:2048
    ds_read_b64_tr_b16 v[74:75], v105 offset:2560
    ds_read_b128 v[84:87], v110 offset:14336
    ds_read_b128 v[88:91], v110 offset:30720
    v_mfma_f32_32x32x16_bf16 v[36:51], v[80:83], v[92:95], v[36:51]
    v_mfma_f32_32x32x16_bf16 v[52:67], v[80:83], v[96:99], v[52:67]
    s_waitcnt lgkmcnt(0)
    v_mfma_f32_32x32x16_bf16 v[4:19], v[68:71], v[84:87], v[4:19]
    s_add_u32 m0, s63, 2048
    s_add_u32 s3, s60, 836608
    buffer_load_dwordx4 v100, s[40:43], s3 offen lds
    buffer_load_dwordx4 v101, s[40:43], s3 offen offset:1024 lds
    v_mfma_f32_32x32x16_bf16 v[20:35], v[68:71], v[88:91], v[20:35]
    s_waitcnt vmcnt(8)
    ds_read_b64_tr_b16 v[76:77], v104 offset:4096
    ds_read_b64_tr_b16 v[78:79], v104 offset:4608
    ds_read_b64_tr_b16 v[80:81], v105 offset:4096
    ds_read_b64_tr_b16 v[82:83], v105 offset:4608
    ds_read_b128 v[92:95], v111 offset:15360
    ds_read_b128 v[96:99], v111 offset:31744
    v_mfma_f32_32x32x16_bf16 v[36:51], v[72:75], v[84:87], v[36:51]
    v_mfma_f32_32x32x16_bf16 v[52:67], v[72:75], v[88:91], v[52:67]
    s_waitcnt lgkmcnt(0)
    v_mfma_f32_32x32x16_bf16 v[4:19], v[76:79], v[92:95], v[4:19]
    s_add_u32 m0, s63, 4096
    s_add_u32 s3, s60, 880640
    buffer_load_dwordx4 v100, s[40:43], s3 offen lds
    buffer_load_dwordx4 v101, s[40:43], s3 offen offset:1024 lds
    v_mfma_f32_32x32x16_bf16 v[20:35], v[76:79], v[96:99], v[20:35]
    s_waitcnt vmcnt(8)
    ds_read_b64_tr_b16 v[68:69], v104 offset:6144
    ds_read_b64_tr_b16 v[70:71], v104 offset:6656
WP1744:
    s_cbranch_execz WP2052
    ds_read_b64_tr_b16 v[72:73], v105 offset:6144
    ds_read_b64_tr_b16 v[74:75], v105 offset:6656
    ds_read_b128 v[84:87], v108 offset:32768
    ds_read_b128 v[88:91], v108 offset:49152
    v_mov_b32 v0, 1
    s_mov_b64 exec, 1
    ds_add_u32 v3, v0 offset:56
    s_mov_b64 exec, -1
    v_mfma_f32_32x32x16_bf16 v[36:51], v[80:83], v[92:95], v[36:51]
    v_mfma_f32_32x32x16_bf16 v[52:67], v[80:83], v[96:99], v[52:67]
    s_waitcnt lgkmcnt(1)
    v_mfma_f32_32x32x16_bf16 v[4:19], v[68:71], v[84:87], v[4:19]
    s_add_u32 m0, s63, 6144
    s_add_u32 s3, s60, 924672
    buffer_load_dwordx4 v100, s[40:43], s3 offen lds
    buffer_load_dwordx4 v101, s[40:43], s3 offen offset:1024 lds
    v_mfma_f32_32x32x16_bf16 v[20:35], v[68:71], v[88:91], v[20:35]
    s_waitcnt vmcnt(8)
    ds_read_b64_tr_b16 v[76:77], v104 offset:8192
    ds_read_b64_tr_b16 v[78:79], v104 offset:8704
    ds_read_b64_tr_b16 v[80:81], v105 offset:8192
    ds_read_b64_tr_b16 v[82:83], v105 offset:8704
    ds_read_b128 v[92:95], v109 offset:33792
    ds_read_b128 v[96:99], v109 offset:50176
    v_mfma_f32_32x32x16_bf16 v[36:51], v[72:75], v[84:87], v[36:51]
    v_mfma_f32_32x32x16_bf16 v[52:67], v[72:75], v[88:91], v[52:67]
    s_waitcnt lgkmcnt(0)
    v_mfma_f32_32x32x16_bf16 v[4:19], v[76:79], v[92:95], v[4:19]
    s_add_u32 m0, s63, 8192
    s_add_u32 s3, s60, 968704
    buffer_load_dwordx4 v100, s[40:43], s3 offen lds
    buffer_load_dwordx4 v101, s[40:43], s3 offen offset:1024 lds
    v_mfma_f32_32x32x16_bf16 v[20:35], v[76:79], v[96:99], v[20:35]
    s_waitcnt vmcnt(8)
    ds_read_b64_tr_b16 v[68:69], v104 offset:0
    ds_read_b64_tr_b16 v[70:71], v104 offset:512
    ds_read_b64_tr_b16 v[72:73], v105 offset:0
    ds_read_b64_tr_b16 v[74:75], v105 offset:512
    ds_read_b128 v[84:87], v110 offset:34816
    ds_read_b128 v[88:91], v110 offset:51200
    v_mfma_f32_32x32x16_bf16 v[36:51], v[80:83], v[92:95], v[36:51]
    v_mfma_f32_32x32x16_bf16 v[52:67], v[80:83], v[96:99], v[52:67]
    s_waitcnt lgkmcnt(0)
    v_mfma_f32_32x32x16_bf16 v[4:19], v[68:71], v[84:87], v[4:19]
    s_add_u32 m0, s63, 0
    s_add_u32 s3, s60, 1012736
    buffer_load_dwordx4 v100, s[40:43], s3 offen lds
    buffer_load_dwordx4 v101, s[40:43], s3 offen offset:1024 lds
    v_mfma_f32_32x32x16_bf16 v[20:35], v[68:71], v[88:91], v[20:35]
    s_waitcnt vmcnt(8)
    ds_read_b64_tr_b16 v[76:77], v104 offset:2048
    ds_read_b64_tr_b16 v[78:79], v104 offset:2560
    ds_read_b64_tr_b16 v[80:81], v105 offset:2048
    ds_read_b64_tr_b16 v[82:83], v105 offset:2560
    ds_read_b128 v[92:95], v111 offset:35840
    ds_read_b128 v[96:99], v111 offset:52224
    v_mfma_f32_32x32x16_bf16 v[36:51], v[72:75], v[84:87], v[36:51]
    v_mfma_f32_32x32x16_bf16 v[52:67], v[72:75], v[88:91], v[52:67]
    s_waitcnt lgkmcnt(0)
    v_mfma_f32_32x32x16_bf16 v[4:19], v[76:79], v[92:95], v[4:19]
    s_add_u32 m0, s63, 2048
    s_add_u32 s3, s60, 1056768
    buffer_load_dwordx4 v100, s[40:43], s3 offen lds
    buffer_load_dwordx4 v101, s[40:43], s3 offen offset:1024 lds
    v_mfma_f32_32x32x16_bf16 v[20:35], v[76:79], v[96:99], v[20:35]
    s_waitcnt vmcnt(8)
    ds_read_b64_tr_b16 v[68:69], v104 offset:4096
    ds_read_b64_tr_b16 v[70:71], v104 offset:4608
    ds_read_b64_tr_b16 v[72:73], v105 offset:4096
    ds_read_b64_tr_b16 v[74:75], v105 offset:4608
    ds_read_b128 v[84:87], v108 offset:36864
    ds_read_b128 v[88:91], v108 offset:53248
    v_mfma_f32_32x32x16_bf16 v[36:51], v[80:83], v[92:95], v[36:51]
    v_mfma_f32_32x32x16_bf16 v[52:67], v[80:83], v[96:99], v[52:67]
    s_waitcnt lgkmcnt(0)
    v_mfma_f32_32x32x16_bf16 v[4:19], v[68:71], v[84:87], v[4:19]
    s_add_u32 m0, s63, 4096
    s_add_u32 s3, s60, 1100800
    buffer_load_dwordx4 v100, s[40:43], s3 offen lds
    buffer_load_dwordx4 v101, s[40:43], s3 offen offset:1024 lds
    v_mfma_f32_32x32x16_bf16 v[20:35], v[68:71], v[88:91], v[20:35]
    s_waitcnt vmcnt(8)
    ds_read_b64_tr_b16 v[76:77], v104 offset:6144
    ds_read_b64_tr_b16 v[78:79], v104 offset:6656
    ds_read_b64_tr_b16 v[80:81], v105 offset:6144
    ds_read_b64_tr_b16 v[82:83], v105 offset:6656
    ds_read_b128 v[92:95], v109 offset:37888
    ds_read_b128 v[96:99], v109 offset:54272
    v_mfma_f32_32x32x16_bf16 v[36:51], v[72:75], v[84:87], v[36:51]
    v_mfma_f32_32x32x16_bf16 v[52:67], v[72:75], v[88:91], v[52:67]
    s_waitcnt lgkmcnt(0)
    v_mfma_f32_32x32x16_bf16 v[4:19], v[76:79], v[92:95], v[4:19]
    s_add_u32 m0, s63, 6144
    s_add_u32 s3, s60, 1144832
    buffer_load_dwordx4 v100, s[40:43], s3 offen lds
    buffer_load_dwordx4 v101, s[40:43], s3 offen offset:1024 lds
    v_mfma_f32_32x32x16_bf16 v[20:35], v[76:79], v[96:99], v[20:35]
    s_waitcnt vmcnt(8)
    ds_read_b64_tr_b16 v[68:69], v104 offset:8192
    ds_read_b64_tr_b16 v[70:71], v104 offset:8704
    ds_read_b64_tr_b16 v[72:73], v105 offset:8192
    ds_read_b64_tr_b16 v[74:75], v105 offset:8704
    ds_read_b128 v[84:87], v110 offset:38912
    ds_read_b128 v[88:91], v110 offset:55296
WP1848:
    s_cbranch_execz WRET2
    v_mfma_f32_32x32x16_bf16 v[36:51], v[80:83], v[92:95], v[36:51]
    v_mfma_f32_32x32x16_bf16 v[52:67], v[80:83], v[96:99], v[52:67]
    s_waitcnt lgkmcnt(0)
    v_mfma_f32_32x32x16_bf16 v[4:19], v[68:71], v[84:87], v[4:19]
    s_add_u32 m0, s63, 8192
    s_add_u32 s3, s60, 1188864
    buffer_load_dwordx4 v100, s[40:43], s3 offen lds
    buffer_load_dwordx4 v101, s[40:43], s3 offen offset:1024 lds
    v_mfma_f32_32x32x16_bf16 v[20:35], v[68:71], v[88:91], v[20:35]
    s_waitcnt vmcnt(8)
    ds_read_b64_tr_b16 v[76:77], v104 offset:0
    ds_read_b64_tr_b16 v[78:79], v104 offset:512
    ds_read_b64_tr_b16 v[80:81], v105 offset:0
    ds_read_b64_tr_b16 v[82:83], v105 offset:512
    ds_read_b128 v[92:95], v111 offset:39936
    ds_read_b128 v[96:99], v111 offset:56320
    v_mfma_f32_32x32x16_bf16 v[36:51], v[72:75], v[84:87], v[36:51]
    v_mfma_f32_32x32x16_bf16 v[52:67], v[72:75], v[88:91], v[52:67]
    s_waitcnt lgkmcnt(0)
    v_mfma_f32_32x32x16_bf16 v[4:19], v[76:79], v[92:95], v[4:19]
    s_add_u32 m0, s63, 0
    s_add_u32 s3, s60, 1232896
    buffer_load_dwordx4 v100, s[40:43], s3 offen lds
    buffer_load_dwordx4 v101, s[40:43], s3 offen offset:1024 lds
    v_mfma_f32_32x32x16_bf16 v[20:35], v[76:79], v[96:99], v[20:35]
    s_waitcnt vmcnt(8)
    ds_read_b64_tr_b16 v[68:69], v104 offset:2048
    ds_read_b64_tr_b16 v[70:71], v104 offset:2560
    ds_read_b64_tr_b16 v[72:73], v105 offset:2048
    ds_read_b64_tr_b16 v[74:75], v105 offset:2560
    ds_read_b128 v[84:87], v108 offset:40960
    ds_read_b128 v[88:91], v108 offset:57344
    v_mfma_f32_32x32x16_bf16 v[36:51], v[80:83], v[92:95], v[36:51]
    v_mfma_f32_32x32x16_bf16 v[52:67], v[80:83], v[96:99], v[52:67]
    s_waitcnt lgkmcnt(0)
    v_mfma_f32_32x32x16_bf16 v[4:19], v[68:71], v[84:87], v[4:19]
    s_add_u32 m0, s63, 2048
    s_add_u32 s3, s60, 1276928
    buffer_load_dwordx4 v100, s[40:43], s3 offen lds
    buffer_load_dwordx4 v101, s[40:43], s3 offen offset:1024 lds
    v_mfma_f32_32x32x16_bf16 v[20:35], v[68:71], v[88:91], v[20:35]
    s_waitcnt vmcnt(8)
    ds_read_b64_tr_b16 v[76:77], v104 offset:4096
    ds_read_b64_tr_b16 v[78:79], v104 offset:4608
    ds_read_b64_tr_b16 v[80:81], v105 offset:4096
    ds_read_b64_tr_b16 v[82:83], v105 offset:4608
    ds_read_b128 v[92:95], v109 offset:41984
    ds_read_b128 v[96:99], v109 offset:58368
    v_mfma_f32_32x32x16_bf16 v[36:51], v[72:75], v[84:87], v[36:51]
    v_mfma_f32_32x32x16_bf16 v[52:67], v[72:75], v[88:91], v[52:67]
    s_waitcnt lgkmcnt(0)
    v_mfma_f32_32x32x16_bf16 v[4:19], v[76:79], v[92:95], v[4:19]
    s_add_u32 m0, s63, 4096
    s_add_u32 s3, s60, 1320960
    buffer_load_dwordx4 v100, s[40:43], s3 offen lds
    buffer_load_dwordx4 v101, s[40:43], s3 offen offset:1024 lds
    v_mfma_f32_32x32x16_bf16 v[20:35], v[76:79], v[96:99], v[20:35]
    s_waitcnt vmcnt(8)
    ds_read_b64_tr_b16 v[68:69], v104 offset:6144
    ds_read_b64_tr_b16 v[70:71], v104 offset:6656
    ds_read_b64_tr_b16 v[72:73], v105 offset:6144
    ds_read_b64_tr_b16 v[74:75], v105 offset:6656
    ds_read_b128 v[84:87], v110 offset:43008
    ds_read_b128 v[88:91], v110 offset:59392
    v_mfma_f32_32x32x16_bf16 v[36:51], v[80:83], v[92:95], v[36:51]
    v_mfma_f32_32x32x16_bf16 v[52:67], v[80:83], v[96:99], v[52:67]
    s_waitcnt lgkmcnt(0)
    v_mfma_f32_32x32x16_bf16 v[4:19], v[68:71], v[84:87], v[4:19]
    s_add_u32 m0, s63, 6144
    s_add_u32 s3, s60, 1364992
    buffer_load_dwordx4 v100, s[40:43], s3 offen lds
    buffer_load_dwordx4 v101, s[40:43], s3 offen offset:1024 lds
    v_mfma_f32_32x32x16_bf16 v[20:35], v[68:71], v[88:91], v[20:35]
    s_waitcnt vmcnt(8)
    ds_read_b64_tr_b16 v[76:77], v104 offset:8192
    ds_read_b64_tr_b16 v[78:79], v104 offset:8704
    ds_read_b64_tr_b16 v[80:81], v105 offset:8192
    ds_read_b64_tr_b16 v[82:83], v105 offset:8704
    ds_read_b128 v[92:95], v111 offset:44032
    ds_read_b128 v[96:99], v111 offset:60416
    v_mfma_f32_32x32x16_bf16 v[36:51], v[72:75], v[84:87], v[36:51]
    v_mfma_f32_32x32x16_bf16 v[52:67], v[72:75], v[88:91], v[52:67]
    s_waitcnt lgkmcnt(0)
    v_mfma_f32_32x32x16_bf16 v[4:19], v[76:79], v[92:95], v[4:19]
    v_mfma_f32_32x32x16_bf16 v[20:35], v[76:79], v[96:99], v[20:35]
    s_waitcnt vmcnt(6)
    ds_read_b64_tr_b16 v[68:69], v104 offset:0
    ds_read_b64_tr_b16 v[70:71], v104 offset:512
    ds_read_b64_tr_b16 v[72:73], v105 offset:0
    ds_read_b64_tr_b16 v[74:75], v105 offset:512
    ds_read_b128 v[84:87], v108 offset:45056
    ds_read_b128 v[88:91], v108 offset:61440
    v_mfma_f32_32x32x16_bf16 v[36:51], v[80:83], v[92:95], v[36:51]
    v_mfma_f32_32x32x16_bf16 v[52:67], v[80:83], v[96:99], v[52:67]
    s_waitcnt lgkmcnt(0)
    v_mfma_f32_32x32x16_bf16 v[4:19], v[68:71], v[84:87], v[4:19]
    v_mfma_f32_32x32x16_bf16 v[20:35], v[68:71], v[88:91], v[20:35]
    s_waitcnt vmcnt(4)
    ds_read_b64_tr_b16 v[76:77], v104 offset:2048
    ds_read_b64_tr_b16 v[78:79], v104 offset:2560
    ds_read_b64_tr_b16 v[80:81], v105 offset:2048
    ds_read_b64_tr_b16 v[82:83], v105 offset:2560
    ds_read_b128 v[92:95], v109 offset:46080
WP1951:
    s_cbranch_execz WRET2
    ds_read_b128 v[96:99], v109 offset:62464
    v_mfma_f32_32x32x16_bf16 v[36:51], v[72:75], v[84:87], v[36:51]
    v_mfma_f32_32x32x16_bf16 v[52:67], v[72:75], v[88:91], v[52:67]
    s_waitcnt lgkmcnt(0)
    v_mfma_f32_32x32x16_bf16 v[4:19], v[76:79], v[92:95], v[4:19]
    v_mfma_f32_32x32x16_bf16 v[20:35], v[76:79], v[96:99], v[20:35]
    s_waitcnt vmcnt(2)
    ds_read_b64_tr_b16 v[68:69], v104 offset:4096
    ds_read_b64_tr_b16 v[70:71], v104 offset:4608
    ds_read_b64_tr_b16 v[72:73], v105 offset:4096
    ds_read_b64_tr_b16 v[74:75], v105 offset:4608
    ds_read_b128 v[84:87], v110 offset:47104
    ds_read_b128 v[88:91], v110 offset:63488
    v_mfma_f32_32x32x16_bf16 v[36:51], v[80:83], v[92:95], v[36:51]
    v_mfma_f32_32x32x16_bf16 v[52:67], v[80:83], v[96:99], v[52:67]
    s_waitcnt lgkmcnt(0)
    v_mfma_f32_32x32x16_bf16 v[4:19], v[68:71], v[84:87], v[4:19]
    v_mfma_f32_32x32x16_bf16 v[20:35], v[68:71], v[88:91], v[20:35]
    s_waitcnt vmcnt(0)
    ds_read_b64_tr_b16 v[76:77], v104 offset:6144
    ds_read_b64_tr_b16 v[78:79], v104 offset:6656
    ds_read_b64_tr_b16 v[80:81], v105 offset:6144
    ds_read_b64_tr_b16 v[82:83], v105 offset:6656
    ds_read_b128 v[92:95], v111 offset:48128
    ds_read_b128 v[96:99], v111 offset:64512
    v_mfma_f32_32x32x16_bf16 v[36:51], v[72:75], v[84:87], v[36:51]
    v_mfma_f32_32x32x16_bf16 v[52:67], v[72:75], v[88:91], v[52:67]
    s_waitcnt lgkmcnt(0)
    v_mfma_f32_32x32x16_bf16 v[4:19], v[76:79], v[92:95], v[4:19]
    v_mfma_f32_32x32x16_bf16 v[20:35], v[76:79], v[96:99], v[20:35]
    v_mov_b32 v0, 1
    s_mov_b64 exec, 1
    ds_add_u32 v3, v0 offset:24
    s_mov_b64 exec, -1
    v_mfma_f32_32x32x16_bf16 v[36:51], v[80:83], v[92:95], v[36:51]
    v_mfma_f32_32x32x16_bf16 v[52:67], v[80:83], v[96:99], v[52:67]
    s_setprio 3
    s_nop 9
    v_cvt_pk_bf16_f32 v112, v4, v5
    v_cvt_pk_bf16_f32 v113, v6, v7
    v_cvt_pk_bf16_f32 v114, v8, v9
    v_cvt_pk_bf16_f32 v115, v10, v11
    v_cvt_pk_bf16_f32 v116, v12, v13
    v_cvt_pk_bf16_f32 v117, v14, v15
    v_cvt_pk_bf16_f32 v118, v16, v17
    v_cvt_pk_bf16_f32 v119, v18, v19
    v_pk_max_i16 v112, v112, 0
    v_pk_max_i16 v113, v113, 0
    v_pk_max_i16 v114, v114, 0
    v_pk_max_i16 v115, v115, 0
    v_pk_max_i16 v116, v116, 0
    v_pk_max_i16 v117, v117, 0
    v_pk_max_i16 v118, v118, 0
    v_pk_max_i16 v119, v119, 0
    buffer_store_dwordx4 v[112:115], v2, s[36:39], s52 offen offset:0 sc1
    buffer_store_dwordx4 v[116:119], v2, s[36:39], s52 offen offset:1024 sc1
    v_cvt_pk_bf16_f32 v120, v20, v21
    v_cvt_pk_bf16_f32 v121, v22, v23
    v_cvt_pk_bf16_f32 v122, v24, v25
    v_cvt_pk_bf16_f32 v123, v26, v27
    v_cvt_pk_bf16_f32 v124, v28, v29
    v_cvt_pk_bf16_f32 v125, v30, v31
    v_cvt_pk_bf16_f32 v126, v32, v33
    v_cvt_pk_bf16_f32 v127, v34, v35
    v_pk_max_i16 v120, v120, 0
    v_pk_max_i16 v121, v121, 0
    v_pk_max_i16 v122, v122, 0
    v_pk_max_i16 v123, v123, 0
    v_pk_max_i16 v124, v124, 0
    v_pk_max_i16 v125, v125, 0
    v_pk_max_i16 v126, v126, 0
    v_pk_max_i16 v127, v127, 0
    buffer_store_dwordx4 v[120:123], v2, s[36:39], s53 offen offset:0 sc1
    buffer_store_dwordx4 v[124:127], v2, s[36:39], s53 offen offset:1024 sc1
    v_cvt_pk_bf16_f32 v128, v36, v37
    v_cvt_pk_bf16_f32 v129, v38, v39
    v_cvt_pk_bf16_f32 v130, v40, v41
    v_cvt_pk_bf16_f32 v131, v42, v43
    v_cvt_pk_bf16_f32 v132, v44, v45
    v_cvt_pk_bf16_f32 v133, v46, v47
    v_cvt_pk_bf16_f32 v134, v48, v49
    v_cvt_pk_bf16_f32 v135, v50, v51
    v_pk_max_i16 v128, v128, 0
    v_pk_max_i16 v129, v129, 0
    v_pk_max_i16 v130, v130, 0
    v_pk_max_i16 v131, v131, 0
    v_pk_max_i16 v132, v132, 0
    v_pk_max_i16 v133, v133, 0
    v_pk_max_i16 v134, v134, 0
    v_pk_max_i16 v135, v135, 0
    buffer_store_dwordx4 v[128:131], v2, s[36:39], s54 offen offset:2048 sc1
    buffer_store_dwordx4 v[132:135], v2, s[36:39], s54 offen offset:3072 sc1
    v_cvt_pk_bf16_f32 v136, v52, v53
    v_cvt_pk_bf16_f32 v137, v54, v55
    v_cvt_pk_bf16_f32 v138, v56, v57
    v_cvt_pk_bf16_f32 v139, v58, v59
    v_cvt_pk_bf16_f32 v140, v60, v61
    v_cvt_pk_bf16_f32 v141, v62, v63
    v_cvt_pk_bf16_f32 v142, v64, v65
    v_cvt_pk_bf16_f32 v143, v66, v67
    v_pk_max_i16 v136, v136, 0
WP2052:
    s_cbranch_execz WRET2
    v_pk_max_i16 v137, v137, 0
    v_pk_max_i16 v138, v138, 0
    v_pk_max_i16 v139, v139, 0
    v_pk_max_i16 v140, v140, 0
    v_pk_max_i16 v141, v141, 0
    v_pk_max_i16 v142, v142, 0
    v_pk_max_i16 v143, v143, 0
    buffer_store_dwordx4 v[136:139], v2, s[36:39], s55 offen offset:2048 sc1
    buffer_store_dwordx4 v[140:143], v2, s[36:39], s55 offen offset:3072 sc1
G_F1DONE:
    s_branch G_JOIN
G_F1IDLE:
    s_waitcnt vmcnt(0)
    v_mov_b32 v4, 1
    s_mov_b64 exec, 1
    ds_add_u32 v3, v4 offset:596
    s_mov_b64 exec, -1
    v_mov_b32 v4, 1
    s_mov_b64 exec, 1
    ds_add_u32 v3, v4 offset:56
    s_mov_b64 exec, -1
    v_mov_b32 v4, 1
    s_mov_b64 exec, 1
    ds_add_u32 v3, v4 offset:24
    s_mov_b64 exec, -1
    s_branch G_JOIN
G3_START:
WP2079:
    s_cbranch_execz WRET1
    s_load_dword s60, s[24:25], 0x0
    s_and_b32 s52, s27, 1
    s_cmp_eq_u32 s52, 0
    s_cselect_b32 s40, s8, s10
    s_cselect_b32 s41, s9, s11
    s_mov_b32 s42, 0x4000
    s_mov_b32 s43, 0x00020000
    s_mov_b32 m0, 81920
    s_mov_b32 s53, 0
    buffer_load_dwordx4 v2, s[40:43], s53 offen offset:0 lds
    buffer_load_dwordx4 v2, s[40:43], s53 offen offset:1024 lds
    buffer_load_dwordx4 v2, s[40:43], s53 offen offset:2048 lds
    buffer_load_dwordx4 v2, s[40:43], s53 offen offset:3072 lds
    s_mov_b32 m0, 86016
    s_mov_b32 s53, 4096
    buffer_load_dwordx4 v2, s[40:43], s53 offen offset:0 lds
    buffer_load_dwordx4 v2, s[40:43], s53 offen offset:1024 lds
    buffer_load_dwordx4 v2, s[40:43], s53 offen offset:2048 lds
    buffer_load_dwordx4 v2, s[40:43], s53 offen offset:3072 lds
    s_mov_b32 m0, 90112
    s_mov_b32 s53, 8192
    buffer_load_dwordx4 v2, s[40:43], s53 offen offset:0 lds
    buffer_load_dwordx4 v2, s[40:43], s53 offen offset:1024 lds
    buffer_load_dwordx4 v2, s[40:43], s53 offen offset:2048 lds
    buffer_load_dwordx4 v2, s[40:43], s53 offen offset:3072 lds
    s_mov_b32 m0, 94208
    s_mov_b32 s53, 12288
    buffer_load_dwordx4 v2, s[40:43], s53 offen offset:0 lds
    buffer_load_dwordx4 v2, s[40:43], s53 offen offset:1024 lds
    buffer_load_dwordx4 v2, s[40:43], s53 offen offset:2048 lds
    buffer_load_dwordx4 v2, s[40:43], s53 offen offset:3072 lds
    v_lshrrev_b32 v150, 4, v1
    v_and_b32 v151, 15, v1
    v_lshlrev_b32 v152, 10, v151
    v_lshl_add_u32 v152, v150, 4, v152
    s_lshr_b32 s54, s27, 1
    s_lshl_b32 s55, s54, 14
    s_lshl_b32 s53, s26, 16
    s_add_u32 s53, s53, s55
    buffer_load_dwordx4 v[68:71], v152, s[32:35], s53 offen offset:0
    buffer_load_dwordx4 v[72:75], v152, s[32:35], s53 offen offset:64
    buffer_load_dwordx4 v[76:79], v152, s[32:35], s53 offen offset:128
    buffer_load_dwordx4 v[80:83], v152, s[32:35], s53 offen offset:192
    buffer_load_dwordx4 v[84:87], v152, s[32:35], s53 offen offset:256
    buffer_load_dwordx4 v[88:91], v152, s[32:35], s53 offen offset:320
    buffer_load_dwordx4 v[92:95], v152, s[32:35], s53 offen offset:384
    buffer_load_dwordx4 v[96:99], v152, s[32:35], s53 offen offset:448
    buffer_load_dwordx4 v[100:103], v152, s[32:35], s53 offen offset:512
    buffer_load_dwordx4 v[104:107], v152, s[32:35], s53 offen offset:576
    buffer_load_dwordx4 v[108:111], v152, s[32:35], s53 offen offset:640
    buffer_load_dwordx4 v[112:115], v152, s[32:35], s53 offen offset:704
    buffer_load_dwordx4 v[116:119], v152, s[32:35], s53 offen offset:768
    buffer_load_dwordx4 v[120:123], v152, s[32:35], s53 offen offset:832
    buffer_load_dwordx4 v[124:127], v152, s[32:35], s53 offen offset:896
    buffer_load_dwordx4 v[128:131], v152, s[32:35], s53 offen offset:960
    s_barrier
    s_waitcnt lgkmcnt(0)
    s_mul_i32 s60, s60, 0x9E3779B1
    s_add_u32 s60, s60, 0x7F4A7C15
    v_mov_b32 v153, s60
    ds_write_b32 v3, v153 offset:32
    v_bfe_u32 v153, v1, 2, 2
    v_lshl_add_u32 v153, v150, 3, v153
    v_lshlrev_b32 v153, 5, v153
    v_and_b32 v154, 3, v1
    v_lshl_add_u32 v153, v154, 3, v153
    v_add_u32 v153, 81920, v153
    v_mov_b32 v140, 0x3f803f80
    v_mov_b32 v141, 0x3f803f80
    v_mov_b32 v142, 0x3f803f80
    v_mov_b32 v143, 0x3f803f80
    s_waitcnt vmcnt(16)
    ds_read_b64_tr_b16 v[4:5], v153 offset:0
    ds_read_b64_tr_b16 v[6:7], v153 offset:128
    ds_read_b64_tr_b16 v[8:9], v153 offset:1024
    ds_read_b64_tr_b16 v[10:11], v153 offset:1152
    ds_read_b64_tr_b16 v[12:13], v153 offset:2048
    ds_read_b64_tr_b16 v[14:15], v153 offset:2176
    ds_read_b64_tr_b16 v[16:17], v153 offset:3072
    ds_read_b64_tr_b16 v[18:19], v153 offset:3200
    ds_read_b64_tr_b16 v[20:21], v153 offset:4096
    ds_read_b64_tr_b16 v[22:23], v153 offset:4224
    ds_read_b64_tr_b16 v[24:25], v153 offset:5120
    ds_read_b64_tr_b16 v[26:27], v153 offset:5248
    ds_read_b64_tr_b16 v[28:29], v153 offset:6144
    ds_read_b64_tr_b16 v[30:31], v153 offset:6272
    s_waitcnt lgkmcnt(0)
    ds_read_b64_tr_b16 v[32:33], v153 offset:7168
    ds_read_b64_tr_b16 v[34:35], v153 offset:7296
    ds_read_b64_tr_b16 v[36:37], v153 offset:8192
    ds_read_b64_tr_b16 v[38:39], v153 offset:8320
    ds_read_b64_tr_b16 v[40:41], v153 offset:9216
    ds_read_b64_tr_b16 v[42:43], v153 offset:9344
    ds_read_b64_tr_b16 v[44:45], v153 offset:10240
    ds_read_b64_tr_b16 v[46:47], v153 offset:10368
    ds_read_b64_tr_b16 v[48:49], v153 offset:11264
    ds_read_b64_tr_b16 v[50:51], v153 offset:11392
    ds_read_b64_tr_b16 v[52:53], v153 offset:12288
    ds_read_b64_tr_b16 v[54:55], v153 offset:12416
    ds_read_b64_tr_b16 v[56:57], v153 offset:13312
    ds_read_b64_tr_b16 v[58:59], v153 offset:13440
    s_waitcnt lgkmcnt(0)
    ds_read_b64_tr_b16 v[60:61], v153 offset:14336
    ds_read_b64_tr_b16 v[62:63], v153 offset:14464
    ds_read_b64_tr_b16 v[64:65], v153 offset:15360
    ds_read_b64_tr_b16 v[66:67], v153 offset:15488
WP2185:
    s_cbranch_execz WRET1
    s_waitcnt lgkmcnt(0)
    v_mov_b32 v154, 1
    s_mov_b64 exec, 1
    ds_add_u32 v3, v154 offset:8
    s_mov_b64 exec, -1
    v_mov_b32 v154, 1
    s_mov_b64 exec, 1
    ds_add_u32 v3, v154 offset:0
    s_mov_b64 exec, -1
    s_setprio 1
    s_lshr_b32 s57, s54, 1
    s_lshl_b32 s56, s57, 5
    s_add_u32 s56, s56, s26
    s_lshl_b32 s59, s56, 2
    s_and_b32 s57, s27, 3
    s_add_u32 s59, s59, s57
    s_lshl_b32 s63, s59, 10
    s_add_u32 s63, s63, 0x40000
    s_cmp_lt_u32 s56, 16
    s_cselect_b32 s63, s63, 0x7f000000
    s_lshl_b32 s59, s59, 7
    s_add_u32 s59, s59, 0xc00000
    s_lshl_b32 s56, s56, 11
    s_add_u32 s56, s56, 0x10000
    s_and_b32 s57, s54, 1
    s_lshl_b32 s58, s54, 7
    s_add_u32 s58, s58, 161856
    s_cmp_eq_u32 s52, 0
    s_cbranch_scc0 G3_V
    v_mfma_f32_16x16x32_bf16 v[136:139], v[4:7], v[140:143], 0
    v_mfma_f32_16x16x32_bf16 v[136:139], v[8:11], v[140:143], v[136:139]
    v_mfma_f32_16x16x32_bf16 v[136:139], v[12:15], v[140:143], v[136:139]
    v_mfma_f32_16x16x32_bf16 v[136:139], v[16:19], v[140:143], v[136:139]
    v_mfma_f32_16x16x32_bf16 v[136:139], v[20:23], v[140:143], v[136:139]
    v_mfma_f32_16x16x32_bf16 v[136:139], v[24:27], v[140:143], v[136:139]
    v_mfma_f32_16x16x32_bf16 v[136:139], v[28:31], v[140:143], v[136:139]
    v_mfma_f32_16x16x32_bf16 v[136:139], v[32:35], v[140:143], v[136:139]
    v_mfma_f32_16x16x32_bf16 v[136:139], v[36:39], v[140:143], v[136:139]
    v_mfma_f32_16x16x32_bf16 v[136:139], v[40:43], v[140:143], v[136:139]
    v_mfma_f32_16x16x32_bf16 v[136:139], v[44:47], v[140:143], v[136:139]
    v_mfma_f32_16x16x32_bf16 v[136:139], v[48:51], v[140:143], v[136:139]
    v_mfma_f32_16x16x32_bf16 v[136:139], v[52:55], v[140:143], v[136:139]
    v_mfma_f32_16x16x32_bf16 v[136:139], v[56:59], v[140:143], v[136:139]
    v_mfma_f32_16x16x32_bf16 v[136:139], v[60:63], v[140:143], v[136:139]
    v_mfma_f32_16x16x32_bf16 v[136:139], v[64:67], v[140:143], v[136:139]
    v_lshlrev_b32 v154, 3, v151
    v_add_u32 v154, s58, v154
    v_lshrrev_b32 v155, 1, v150
    v_lshlrev_b32 v155, 9, v155
    v_lshl_add_u32 v155, v151, 4, v155
    v_and_b32 v156, 1, v150
    v_lshl_add_u32 v155, v156, 3, v155
    s_lshl_b32 s57, s57, 8
    s_add_u32 s56, s56, s57
    v_and_b32 v157, 255, v155
    v_add_u32 v157, v157, v155
    s_waitcnt vmcnt(15)
    v_mfma_f32_16x16x32_bf16 v[132:135], v[4:7], v[68:71], 0
    s_waitcnt vmcnt(14)
    v_mfma_f32_16x16x32_bf16 v[132:135], v[8:11], v[72:75], v[132:135]
    s_waitcnt vmcnt(13)
    v_mfma_f32_16x16x32_bf16 v[132:135], v[12:15], v[76:79], v[132:135]
    s_waitcnt vmcnt(12)
    v_mfma_f32_16x16x32_bf16 v[132:135], v[16:19], v[80:83], v[132:135]
    s_waitcnt vmcnt(11)
    v_mfma_f32_16x16x32_bf16 v[132:135], v[20:23], v[84:87], v[132:135]
    s_waitcnt vmcnt(10)
    v_mfma_f32_16x16x32_bf16 v[132:135], v[24:27], v[88:91], v[132:135]
    s_waitcnt vmcnt(9)
    v_mfma_f32_16x16x32_bf16 v[132:135], v[28:31], v[92:95], v[132:135]
    s_waitcnt vmcnt(8)
    v_mfma_f32_16x16x32_bf16 v[132:135], v[32:35], v[96:99], v[132:135]
    s_waitcnt vmcnt(7)
    v_mfma_f32_16x16x32_bf16 v[132:135], v[36:39], v[100:103], v[132:135]
    s_waitcnt vmcnt(6)
    v_mfma_f32_16x16x32_bf16 v[132:135], v[40:43], v[104:107], v[132:135]
    s_waitcnt vmcnt(5)
    v_mfma_f32_16x16x32_bf16 v[132:135], v[44:47], v[108:111], v[132:135]
    s_waitcnt vmcnt(4)
    v_mfma_f32_16x16x32_bf16 v[132:135], v[48:51], v[112:115], v[132:135]
    s_waitcnt vmcnt(3)
    v_mfma_f32_16x16x32_bf16 v[132:135], v[52:55], v[116:119], v[132:135]
    s_waitcnt vmcnt(2)
    v_mfma_f32_16x16x32_bf16 v[132:135], v[56:59], v[120:123], v[132:135]
    s_waitcnt vmcnt(1)
    v_mfma_f32_16x16x32_bf16 v[132:135], v[60:63], v[124:127], v[132:135]
    s_waitcnt vmcnt(0)
    v_mfma_f32_16x16x32_bf16 v[132:135], v[64:67], v[128:131], v[132:135]
    s_mov_b32 s31, 0x40000
STS_12:
    ds_read_b64 v[140:141], v154
    s_sub_u32 s31, s31, 1
    s_cbranch_scc1 STS_12_X
    s_waitcnt lgkmcnt(0)
    v_cmp_eq_u32 vcc, 0, v141
    s_cmp_eq_u64 vcc, 0
    s_cbranch_scc1 STS_12_X
    s_sleep 1
    s_branch STS_12
STS_12_X:
    s_waitcnt lgkmcnt(0)
    v_mul_f32 v140, 0x3eb8aa3b, v140
    v_mul_f32 v141, 0x3eb8aa3b, v141
    v_mul_f32 v132, v132, v141
    v_fma_f32 v132, -v140, v136, v132
    v_mul_f32 v133, v133, v141
    v_fma_f32 v133, -v140, v137, v133
    v_mul_f32 v134, v134, v141
    v_fma_f32 v134, -v140, v138, v134
    v_mul_f32 v135, v135, v141
    v_fma_f32 v135, -v140, v139, v135
    v_cvt_pk_bf16_f32 v132, v132, v133
    v_cvt_pk_bf16_f32 v133, v134, v135
    s_branch G3_PUB
G3_V:
    v_mfma_f32_16x16x32_bf16 v[136:139], v[140:143], v[4:7], 0
    v_mfma_f32_16x16x32_bf16 v[136:139], v[140:143], v[8:11], v[136:139]
    v_mfma_f32_16x16x32_bf16 v[136:139], v[140:143], v[12:15], v[136:139]
    v_mfma_f32_16x16x32_bf16 v[136:139], v[140:143], v[16:19], v[136:139]
    v_mfma_f32_16x16x32_bf16 v[136:139], v[140:143], v[20:23], v[136:139]
    v_mfma_f32_16x16x32_bf16 v[136:139], v[140:143], v[24:27], v[136:139]
    v_mfma_f32_16x16x32_bf16 v[136:139], v[140:143], v[28:31], v[136:139]
    v_mfma_f32_16x16x32_bf16 v[136:139], v[140:143], v[32:35], v[136:139]
    v_mfma_f32_16x16x32_bf16 v[136:139], v[140:143], v[36:39], v[136:139]
    v_mfma_f32_16x16x32_bf16 v[136:139], v[140:143], v[40:43], v[136:139]
    v_mfma_f32_16x16x32_bf16 v[136:139], v[140:143], v[44:47], v[136:139]
    v_mfma_f32_16x16x32_bf16 v[136:139], v[140:143], v[48:51], v[136:139]
    v_mfma_f32_16x16x32_bf16 v[136:139], v[140:143], v[52:55], v[136:139]
    v_mfma_f32_16x16x32_bf16 v[136:139], v[140:143], v[56:59], v[136:139]
WP2314:
    s_cbranch_execz WRET1
    v_mfma_f32_16x16x32_bf16 v[136:139], v[140:143], v[60:63], v[136:139]
    v_mfma_f32_16x16x32_bf16 v[136:139], v[140:143], v[64:67], v[136:139]
    v_lshlrev_b32 v154, 5, v150
    v_add_u32 v154, s58, v154
    v_lshrrev_b32 v155, 1, v150
    v_lshlrev_b32 v155, 9, v155
    v_lshl_add_u32 v155, v151, 4, v155
    v_and_b32 v156, 1, v150
    v_lshl_add_u32 v155, v156, 3, v155
    s_lshl_b32 s57, s57, 8
    s_sub_u32 s56, s56, s57
    s_add_u32 s56, s56, 1280
    v_and_b32 v157, 255, v155
    v_add_u32 v157, v157, v155
    s_waitcnt vmcnt(15)
    v_mfma_f32_16x16x32_bf16 v[132:135], v[68:71], v[4:7], 0
    s_waitcnt vmcnt(14)
    v_mfma_f32_16x16x32_bf16 v[132:135], v[72:75], v[8:11], v[132:135]
    s_waitcnt vmcnt(13)
    v_mfma_f32_16x16x32_bf16 v[132:135], v[76:79], v[12:15], v[132:135]
    s_waitcnt vmcnt(12)
    v_mfma_f32_16x16x32_bf16 v[132:135], v[80:83], v[16:19], v[132:135]
    s_waitcnt vmcnt(11)
    v_mfma_f32_16x16x32_bf16 v[132:135], v[84:87], v[20:23], v[132:135]
    s_waitcnt vmcnt(10)
    v_mfma_f32_16x16x32_bf16 v[132:135], v[88:91], v[24:27], v[132:135]
    s_waitcnt vmcnt(9)
    v_mfma_f32_16x16x32_bf16 v[132:135], v[92:95], v[28:31], v[132:135]
    s_waitcnt vmcnt(8)
    v_mfma_f32_16x16x32_bf16 v[132:135], v[96:99], v[32:35], v[132:135]
    s_waitcnt vmcnt(7)
    v_mfma_f32_16x16x32_bf16 v[132:135], v[100:103], v[36:39], v[132:135]
    s_waitcnt vmcnt(6)
    v_mfma_f32_16x16x32_bf16 v[132:135], v[104:107], v[40:43], v[132:135]
    s_waitcnt vmcnt(5)
    v_mfma_f32_16x16x32_bf16 v[132:135], v[108:111], v[44:47], v[132:135]
    s_waitcnt vmcnt(4)
    v_mfma_f32_16x16x32_bf16 v[132:135], v[112:115], v[48:51], v[132:135]
    s_waitcnt vmcnt(3)
    v_mfma_f32_16x16x32_bf16 v[132:135], v[116:119], v[52:55], v[132:135]
    s_waitcnt vmcnt(2)
    v_mfma_f32_16x16x32_bf16 v[132:135], v[120:123], v[56:59], v[132:135]
    s_waitcnt vmcnt(1)
    v_mfma_f32_16x16x32_bf16 v[132:135], v[124:127], v[60:63], v[132:135]
    s_waitcnt vmcnt(0)
    v_mfma_f32_16x16x32_bf16 v[132:135], v[128:131], v[64:67], v[132:135]
    s_mov_b32 s31, 0x40000
STS_13:
    ds_read_b128 v[140:143], v154
    ds_read_b128 v[144:147], v154 offset:16
    s_sub_u32 s31, s31, 1
    s_cbranch_scc1 STS_13_X
    s_waitcnt lgkmcnt(0)
    v_min_u32 v156, v141, v143
    v_min3_u32 v156, v145, v147, v156
    v_cmp_eq_u32 vcc, 0, v156
    s_cmp_eq_u64 vcc, 0
    s_cbranch_scc1 STS_13_X
    s_sleep 1
    s_branch STS_13
STS_13_X:
    s_waitcnt lgkmcnt(0)
    v_mul_f32 v132, v132, v141
    v_fma_f32 v132, -v140, v136, v132
    v_mul_f32 v133, v133, v143
    v_fma_f32 v133, -v142, v137, v133
    v_mul_f32 v134, v134, v145
    v_fma_f32 v134, -v144, v138, v134
    v_mul_f32 v135, v135, v147
    v_fma_f32 v135, -v146, v139, v135
    v_cvt_pk_bf16_f32 v132, v132, v133
    v_cvt_pk_bf16_f32 v133, v134, v135
G3_PUB:
    s_setprio 3
    v_mov_b32 v134, s60
    v_mov_b32 v135, s60
    buffer_store_dwordx4 v[132:135], v157, s[36:39], s63 offen sc1
    buffer_store_dwordx2 v[132:133], v155, s[36:39], s56 offen sc1
    s_mov_b32 s58, 0xc00000
    v_lshlrev_b32 v6, 7, v1
    s_and_b32 s57, s2, 0
    s_lshl_b32 s57, s57, 15
    v_add_u32 v6, s57, v6
    v_mov_b32 v4, s60
    v_lshlrev_b32 v5, 15, v1
    s_mov_b64 exec, 0x1
    s_waitcnt vmcnt(0)
    buffer_store_dword v4, v5, s[36:39], s59 offen sc1
    s_mov_b64 exec, -1
    s_mov_b64 exec, 0
    s_cmp_eq_u32 s28, 11
    s_cbranch_scc1 WP2669
WRET3:
    s_mov_b64 exec, -1
    s_mov_b32 s31, 0x40000
SP_14:
    ds_read_b32 v4, v3 offset:4
    s_sub_u32 s31, s31, 1
    s_waitcnt lgkmcnt(0)
    v_readfirstlane_b32 s30, v4
    s_cbranch_scc1 SP_14_X
    s_cmp_ge_u32 s30, 8
    s_cbranch_scc1 SP_14_X
    s_sleep 1
    s_branch SP_14
SP_14_X:
    s_mov_b32 s58, 0xc02000
    s_mov_b32 s31, 0x1000
GP_15:
    buffer_load_dword v4, v6, s[36:39], s58 offen sc1
    s_sub_u32 s31, s31, 1
    s_cbranch_scc1 GP_15_X
    s_waitcnt vmcnt(0)
    v_cmp_ne_u32 vcc, s60, v4
    s_cmp_eq_u64 vcc, 0
    s_cbranch_scc1 GP_15_X
    s_sleep 2
    s_branch GP_15
GP_15_X:
    s_waitcnt vmcnt(0)
    s_mov_b32 s31, 0x40000
SP_16:
    ds_read_b32 v4, v3 offset:4
    s_sub_u32 s31, s31, 1
    s_waitcnt lgkmcnt(0)
    v_readfirstlane_b32 s30, v4
    s_cbranch_scc1 SP_16_X
    s_cmp_ge_u32 s30, 8
    s_cbranch_scc1 SP_16_X
    s_sleep 1
    s_branch SP_16
SP_16_X:
    s_mov_b32 m0, 32768
    s_mov_b32 s53, 0x18000
    buffer_load_dwordx4 v2, s[36:39], s53 offen offset:0 sc1 lds
    buffer_load_dwordx4 v2, s[36:39], s53 offen offset:1024 sc1 lds
    buffer_load_dwordx4 v2, s[36:39], s53 offen offset:2048 sc1 lds
    buffer_load_dwordx4 v2, s[36:39], s53 offen offset:3072 sc1 lds
    s_mov_b32 m0, 36864
    s_mov_b32 s53, 0x19000
    buffer_load_dwordx4 v2, s[36:39], s53 offen offset:0 sc1 lds
    buffer_load_dwordx4 v2, s[36:39], s53 offen offset:1024 sc1 lds
    buffer_load_dwordx4 v2, s[36:39], s53 offen offset:2048 sc1 lds
    buffer_load_dwordx4 v2, s[36:39], s53 offen offset:3072 sc1 lds
    s_mov_b32 m0, 40960
    s_mov_b32 s53, 0x1a000
    buffer_load_dwordx4 v2, s[36:39], s53 offen offset:0 sc1 lds
WP2457:
    s_cbranch_execz WRET1
    buffer_load_dwordx4 v2, s[36:39], s53 offen offset:1024 sc1 lds
    buffer_load_dwordx4 v2, s[36:39], s53 offen offset:2048 sc1 lds
    buffer_load_dwordx4 v2, s[36:39], s53 offen offset:3072 sc1 lds
    s_mov_b32 m0, 45056
    s_mov_b32 s53, 0x1b000
    buffer_load_dwordx4 v2, s[36:39], s53 offen offset:0 sc1 lds
    buffer_load_dwordx4 v2, s[36:39], s53 offen offset:1024 sc1 lds
    buffer_load_dwordx4 v2, s[36:39], s53 offen offset:2048 sc1 lds
    buffer_load_dwordx4 v2, s[36:39], s53 offen offset:3072 sc1 lds
    s_mov_b32 m0, 49152
    s_mov_b32 s53, 0x1c000
    buffer_load_dwordx4 v2, s[36:39], s53 offen offset:0 sc1 lds
    buffer_load_dwordx4 v2, s[36:39], s53 offen offset:1024 sc1 lds
    buffer_load_dwordx4 v2, s[36:39], s53 offen offset:2048 sc1 lds
    buffer_load_dwordx4 v2, s[36:39], s53 offen offset:3072 sc1 lds
    s_mov_b32 m0, 53248
    s_mov_b32 s53, 0x1d000
    buffer_load_dwordx4 v2, s[36:39], s53 offen offset:0 sc1 lds
    buffer_load_dwordx4 v2, s[36:39], s53 offen offset:1024 sc1 lds
    buffer_load_dwordx4 v2, s[36:39], s53 offen offset:2048 sc1 lds
    buffer_load_dwordx4 v2, s[36:39], s53 offen offset:3072 sc1 lds
    s_mov_b32 m0, 57344
    s_mov_b32 s53, 0x1e000
    buffer_load_dwordx4 v2, s[36:39], s53 offen offset:0 sc1 lds
    buffer_load_dwordx4 v2, s[36:39], s53 offen offset:1024 sc1 lds
    buffer_load_dwordx4 v2, s[36:39], s53 offen offset:2048 sc1 lds
    buffer_load_dwordx4 v2, s[36:39], s53 offen offset:3072 sc1 lds
    s_mov_b32 m0, 61440
    s_mov_b32 s53, 0x1f000
    buffer_load_dwordx4 v2, s[36:39], s53 offen offset:0 sc1 lds
    buffer_load_dwordx4 v2, s[36:39], s53 offen offset:1024 sc1 lds
    buffer_load_dwordx4 v2, s[36:39], s53 offen offset:2048 sc1 lds
    buffer_load_dwordx4 v2, s[36:39], s53 offen offset:3072 sc1 lds
    v_mov_b64 v[8:9], -1
    v_mov_b64 v[10:11], -1
    s_mul_i32 s53, s26, 236
    s_lshl_b32 s57, s27, 2
    s_add_u32 s53, s53, s57
    s_lshl_b32 s53, s53, 10
    s_add_u32 s53, s53, 0x115800
    s_add_u32 s57, s53, 120832
    buffer_store_dwordx4 v[8:11], v2, s[36:39], s53 offen offset:0 sc1
    buffer_store_dwordx4 v[8:11], v2, s[36:39], s53 offen offset:1024 sc1
    buffer_store_dwordx4 v[8:11], v2, s[36:39], s53 offen offset:2048 sc1
    buffer_store_dwordx4 v[8:11], v2, s[36:39], s53 offen offset:3072 sc1
    buffer_store_dwordx4 v[8:11], v2, s[36:39], s57 offen offset:0 sc1
    buffer_store_dwordx4 v[8:11], v2, s[36:39], s57 offen offset:1024 sc1
    buffer_store_dwordx4 v[8:11], v2, s[36:39], s57 offen offset:2048 sc1
    buffer_store_dwordx4 v[8:11], v2, s[36:39], s57 offen offset:3072 sc1
    s_waitcnt vmcnt(8)
    v_mov_b32 v4, 1
    s_mov_b64 exec, 1
    ds_add_u32 v3, v4 offset:16
    s_mov_b64 exec, -1
    s_mov_b32 s58, 0xc04000
    s_mov_b32 s31, 0x1000
GP_17:
    buffer_load_dword v4, v6, s[36:39], s58 offen sc1
    s_sub_u32 s31, s31, 1
    s_cbranch_scc1 GP_17_X
    s_waitcnt vmcnt(0)
    v_cmp_ne_u32 vcc, s60, v4
    s_cmp_eq_u64 vcc, 0
    s_cbranch_scc1 GP_17_X
    s_sleep 2
    s_branch GP_17
GP_17_X:
    s_waitcnt vmcnt(0)
    s_mov_b32 s58, 0xc06000
    s_mov_b32 s31, 0x1000
GP_18:
    buffer_load_dword v4, v6, s[36:39], s58 offen sc1
    s_sub_u32 s31, s31, 1
    s_cbranch_scc1 GP_18_X
    s_waitcnt vmcnt(0)
    v_cmp_ne_u32 vcc, s60, v4
    s_cmp_eq_u64 vcc, 0
    s_cbranch_scc1 GP_18_X
    s_sleep 2
    s_branch GP_18
GP_18_X:
    s_waitcnt vmcnt(0)
    v_mov_b32 v4, 1
    s_mov_b64 exec, 1
    ds_add_u32 v3, v4 offset:36
    s_mov_b64 exec, -1
    s_getreg_b32 s63, hwreg(HW_REG_XCC_ID, 0, 4)
    s_lshl_b32 s57, s29, 7
    s_add_u32 s57, s57, 0xb40000
    s_mov_b32 s31, 0x40000
SP_19:
    ds_read_b32 v4, v3 offset:596
    s_sub_u32 s31, s31, 1
    s_waitcnt lgkmcnt(0)
    v_readfirstlane_b32 s30, v4
    s_cbranch_scc1 SP_19_X
    s_cmp_ge_u32 s30, 3
    s_cbranch_scc1 SP_19_X
    s_sleep 2
    s_branch SP_19
SP_19_X:
    v_mov_b32 v4, s60
    v_mov_b32 v5, s63
    v_mov_b32 v6, 0
    s_mov_b64 exec, 1
    buffer_store_dwordx2 v[4:5], v6, s[36:39], s57 offen sc1
    s_mov_b64 exec, -1
    s_nop 0
    s_mov_b32 s31, 0x40000
SP_20:
    ds_read_b32 v4, v3 offset:56
    s_sub_u32 s31, s31, 1
    s_waitcnt lgkmcnt(0)
    v_readfirstlane_b32 s30, v4
    s_cbranch_scc1 SP_20_X
    s_cmp_ge_u32 s30, 3
    s_cbranch_scc1 SP_20_X
    s_sleep 2
    s_branch SP_20
SP_20_X:
    s_mov_b32 m0, 65536
    s_mov_b32 s53, 0x20000
    buffer_load_dwordx4 v2, s[36:39], s53 offen offset:0 sc1 lds
    buffer_load_dwordx4 v2, s[36:39], s53 offen offset:1024 sc1 lds
    buffer_load_dwordx4 v2, s[36:39], s53 offen offset:2048 sc1 lds
    buffer_load_dwordx4 v2, s[36:39], s53 offen offset:3072 sc1 lds
    s_mov_b32 m0, 69632
    s_mov_b32 s53, 0x21000
    buffer_load_dwordx4 v2, s[36:39], s53 offen offset:0 sc1 lds
    buffer_load_dwordx4 v2, s[36:39], s53 offen offset:1024 sc1 lds
    buffer_load_dwordx4 v2, s[36:39], s53 offen offset:2048 sc1 lds
WP2588:
    s_cbranch_execz WRET1
    buffer_load_dwordx4 v2, s[36:39], s53 offen offset:3072 sc1 lds
    s_mov_b32 m0, 73728
    s_mov_b32 s53, 0x22000
    buffer_load_dwordx4 v2, s[36:39], s53 offen offset:0 sc1 lds
    buffer_load_dwordx4 v2, s[36:39], s53 offen offset:1024 sc1 lds
    buffer_load_dwordx4 v2, s[36:39], s53 offen offset:2048 sc1 lds
    buffer_load_dwordx4 v2, s[36:39], s53 offen offset:3072 sc1 lds
    s_mov_b32 m0, 77824
    s_mov_b32 s53, 0x23000
    buffer_load_dwordx4 v2, s[36:39], s53 offen offset:0 sc1 lds
    buffer_load_dwordx4 v2, s[36:39], s53 offen offset:1024 sc1 lds
    buffer_load_dwordx4 v2, s[36:39], s53 offen offset:2048 sc1 lds
    buffer_load_dwordx4 v2, s[36:39], s53 offen offset:3072 sc1 lds
    s_mov_b32 m0, 81920
    s_mov_b32 s53, 0x24000
    buffer_load_dwordx4 v2, s[36:39], s53 offen offset:0 sc1 lds
    buffer_load_dwordx4 v2, s[36:39], s53 offen offset:1024 sc1 lds
    buffer_load_dwordx4 v2, s[36:39], s53 offen offset:2048 sc1 lds
    buffer_load_dwordx4 v2, s[36:39], s53 offen offset:3072 sc1 lds
    s_mov_b32 m0, 86016
    s_mov_b32 s53, 0x25000
    buffer_load_dwordx4 v2, s[36:39], s53 offen offset:0 sc1 lds
    buffer_load_dwordx4 v2, s[36:39], s53 offen offset:1024 sc1 lds
    buffer_load_dwordx4 v2, s[36:39], s53 offen offset:2048 sc1 lds
    buffer_load_dwordx4 v2, s[36:39], s53 offen offset:3072 sc1 lds
    s_mov_b32 m0, 90112
    s_mov_b32 s53, 0x26000
    buffer_load_dwordx4 v2, s[36:39], s53 offen offset:0 sc1 lds
    buffer_load_dwordx4 v2, s[36:39], s53 offen offset:1024 sc1 lds
    buffer_load_dwordx4 v2, s[36:39], s53 offen offset:2048 sc1 lds
    buffer_load_dwordx4 v2, s[36:39], s53 offen offset:3072 sc1 lds
    s_mov_b32 m0, 94208
    s_mov_b32 s53, 0x27000
    buffer_load_dwordx4 v2, s[36:39], s53 offen offset:0 sc1 lds
    buffer_load_dwordx4 v2, s[36:39], s53 offen offset:1024 sc1 lds
    buffer_load_dwordx4 v2, s[36:39], s53 offen offset:2048 sc1 lds
    buffer_load_dwordx4 v2, s[36:39], s53 offen offset:3072 sc1 lds
    s_waitcnt vmcnt(0)
    v_mov_b32 v4, 1
    s_mov_b64 exec, 1
    ds_add_u32 v3, v4 offset:60
    s_mov_b64 exec, -1
    s_lshl_b32 s52, s26, 3
    v_add_u32 v4, s52, v1
    v_subrev_u32 v5, 8, v1
    v_lshlrev_b32 v5, 3, v5
    v_add_u32 v5, s27, v5
    v_mov_b32 v6, s29
    v_cmp_gt_u32 vcc, 40, v1
    s_nop 1
    v_cndmask_b32 v5, v6, v5, vcc
    v_cmp_gt_u32 vcc, 8, v1
    s_nop 1
    v_cndmask_b32 v5, v5, v4, vcc
    v_lshlrev_b32 v5, 7, v5
    s_mov_b32 s58, 0xb40000
    s_mov_b32 s31, 0x1000
GP_21:
    buffer_load_dwordx2 v[6:7], v5, s[36:39], s58 offen sc1
    s_sub_u32 s31, s31, 1
    s_cbranch_scc1 GP_21_X
    s_waitcnt vmcnt(0)
    v_cmp_ne_u32 vcc, s60, v6
    s_cmp_eq_u64 vcc, 0
    s_cbranch_scc1 GP_21_X
    s_sleep 4
    s_branch GP_21
GP_21_X:
    s_waitcnt vmcnt(0)
    v_cmp_ne_u32 vcc, s63, v7
    v_cmp_ne_u32 s[64:65], s60, v6
    s_or_b64 vcc, vcc, s[64:65]
    s_and_b32 s30, vcc_lo, 0xff
    s_cselect_b32 s30, 0, 1
    v_mov_b32 v4, s30
    ds_write_b32 v3, v4 offset:52
    v_mov_b32 v4, 1
    s_mov_b64 exec, 1
    ds_add_u32 v3, v4 offset:600
    s_mov_b64 exec, -1
G_JOIN:
WP2669:
    s_cbranch_execz WP2823
    s_mov_b32 s31, 0x40000
SP_22:
    ds_read_b32 v4, v3 offset:24
    s_sub_u32 s31, s31, 1
    s_waitcnt lgkmcnt(0)
    v_readfirstlane_b32 s30, v4
    s_cbranch_scc1 SP_22_X
    s_cmp_ge_u32 s30, 3
    s_cbranch_scc1 SP_22_X
    s_sleep 1
    s_branch SP_22
SP_22_X:
    s_mov_b32 s31, 0x40000
SP_23:
    ds_read_b32 v4, v3 offset:36
    s_sub_u32 s31, s31, 1
    s_waitcnt lgkmcnt(0)
    v_readfirstlane_b32 s30, v4
    s_cbranch_scc1 SP_23_X
    s_cmp_ge_u32 s30, 1
    s_cbranch_scc1 SP_23_X
    s_sleep 1
    s_branch SP_23
SP_23_X:
    ds_read_b32 v4, v3 offset:32
    s_waitcnt lgkmcnt(0)
    v_readfirstlane_b32 s61, v4
    s_lshl_b32 s52, s62, 12
    s_add_u32 m0, s52, 98304
    s_add_u32 s53, s52, 0x28000
    buffer_load_dwordx4 v2, s[36:39], s53 offen offset:0 sc1 lds
    buffer_load_dwordx4 v2, s[36:39], s53 offen offset:1024 sc1 lds
    buffer_load_dwordx4 v2, s[36:39], s53 offen offset:2048 sc1 lds
    buffer_load_dwordx4 v2, s[36:39], s53 offen offset:3072 sc1 lds
    s_add_u32 m0, s52, 114688
    s_add_u32 s53, s52, 0x2c000
    buffer_load_dwordx4 v2, s[36:39], s53 offen offset:0 sc1 lds
    buffer_load_dwordx4 v2, s[36:39], s53 offen offset:1024 sc1 lds
    buffer_load_dwordx4 v2, s[36:39], s53 offen offset:2048 sc1 lds
    buffer_load_dwordx4 v2, s[36:39], s53 offen offset:3072 sc1 lds
    s_cmp_eq_u32 s62, 3
    s_cbranch_scc1 G_NOFLAG
    s_waitcnt vmcnt(8)
    v_mov_b32 v4, 1
    s_mov_b64 exec, 1
    ds_add_rtn_u32 v5, v3, v4 offset:28
    s_mov_b64 exec, -1
    s_lshl_b32 s57, s29, 7
    s_add_u32 s57, s57, 0xb80000
    s_waitcnt lgkmcnt(0)
    v_readfirstlane_b32 s30, v5
    s_cmp_eq_u32 s30, 2
    s_cbranch_scc0 G_NOFLAG
    v_mov_b32 v4, s61
    v_mov_b32 v5, 0
    s_mov_b64 exec, 1
    buffer_store_dword v4, v5, s[36:39], s57 offen sc1
    s_mov_b64 exec, -1
G_NOFLAG:
    s_lshl_b32 s52, s26, 3
    v_and_b32 v5, 7, v1
    v_add_u32 v5, s52, v5
    v_lshlrev_b32 v5, 7, v5
    s_mul_i32 s52, s27, 241664
    s_add_u32 s52, s52, 0x900000
    s_mul_i32 s53, s26, 241664
    s_add_u32 s53, s53, 0x100000
    v_add_u32 v164, s52, v2
    v_add_u32 v165, 120832, v164
    v_add_u32 v166, s53, v2
    v_add_u32 v167, 120832, v166
    s_lshl_b32 s54, s62, 10
    s_cmp_eq_u32 s62, 3
    s_cselect_b32 s54, 61440, s54
    s_cselect_b32 s55, 1, 3
    s_cselect_b32 s60, 2, 1
    s_lshl_b32 s55, s55, 10
    s_waitcnt vmcnt(0)
    v_mov_b32 v4, 1
    s_mov_b64 exec, 1
    ds_add_u32 v3, v4 offset:20
    s_mov_b64 exec, -1
    s_mov_b32 s31, 0x40000
SP_24:
    ds_read_b32 v4, v3 offset:600
    s_sub_u32 s31, s31, 1
    s_waitcnt lgkmcnt(0)
    v_readfirstlane_b32 s30, v4
    s_cbranch_scc1 SP_24_X
    s_cmp_ge_u32 s30, 1
    s_cbranch_scc1 SP_24_X
    s_sleep 1
    s_branch SP_24
SP_24_X:
    s_mov_b32 s59, s54
    buffer_load_dwordx4 v[132:135], v164, s[36:39], s59 offen sc1
    buffer_load_dwordx4 v[136:139], v165, s[36:39], s59 offen sc1
    s_add_u32 s59, s59, s55
    buffer_load_dwordx4 v[148:151], v164, s[36:39], s59 offen sc1
    buffer_load_dwordx4 v[152:155], v165, s[36:39], s59 offen sc1
    s_add_u32 s59, s59, s55
    buffer_load_dwordx4 v[68:71], v164, s[36:39], s59 offen sc1
    buffer_load_dwordx4 v[72:75], v165, s[36:39], s59 offen sc1
    s_add_u32 s59, s59, s55
    buffer_load_dwordx4 v[84:87], v164, s[36:39], s59 offen sc1
    buffer_load_dwordx4 v[88:91], v165, s[36:39], s59 offen sc1
    s_add_u32 s59, s59, s55
    buffer_load_dwordx4 v[100:103], v164, s[36:39], s59 offen sc1
    buffer_load_dwordx4 v[104:107], v165, s[36:39], s59 offen sc1
    s_add_u32 s59, s59, s55
    buffer_load_dwordx4 v[116:119], v164, s[36:39], s59 offen sc1
    buffer_load_dwordx4 v[120:123], v165, s[36:39], s59 offen sc1
    s_add_u32 s59, s59, s55
    s_mov_b32 s58, 0xb80000
    s_cmp_eq_u32 s62, 3
    s_cbranch_scc0 G_HW
    s_mov_b32 s31, 0x1000
GP_25:
    buffer_load_dword v4, v5, s[36:39], s58 offen sc1
    s_sub_u32 s31, s31, 1
    s_cbranch_scc1 GP_25_X
    s_waitcnt vmcnt(0)
    v_cmp_ne_u32 vcc, s61, v4
    s_cmp_eq_u64 vcc, 0
    s_cbranch_scc1 GP_25_X
    s_sleep 3
    s_branch GP_25
GP_25_X:
    s_waitcnt vmcnt(0)
    v_mov_b32 v4, 1
    s_mov_b64 exec, 1
    ds_add_u32 v3, v4 offset:40
    s_mov_b64 exec, -1
G_HW:
    s_mov_b32 s31, 0x40000
SP_26:
    ds_read_b32 v4, v3 offset:40
    s_sub_u32 s31, s31, 1
    s_waitcnt lgkmcnt(0)
    v_readfirstlane_b32 s30, v4
    s_cbranch_scc1 SP_26_X
    s_cmp_ge_u32 s30, 1
    s_cbranch_scc1 SP_26_X
    s_sleep 2
    s_branch SP_26
SP_26_X:
    s_setprio 0
    s_lshr_b32 s57, s62, 1
    s_lshl_b32 s57, s57, 12
    s_and_b32 s56, s62, 1
    s_lshl_b32 s56, s56, 10
    s_add_u32 s57, s57, s56
    s_add_u32 s40, s57, 88064
    s_add_u32 s41, s40, 8192
WP2823:
    s_cbranch_execz WP2931
    s_add_u32 s42, s40, 16384
    s_add_u32 s43, s40, 24576
    s_mul_i32 s56, s62, 7168
    s_add_u32 s56, s56, 131072
    buffer_load_dwordx4 v[140:143], v166, s[36:39], s54 offen sc1
    buffer_load_dwordx4 v[144:147], v167, s[36:39], s54 offen sc1
    s_add_u32 s54, s54, s55
    buffer_load_dwordx4 v[156:159], v166, s[36:39], s54 offen sc1
    buffer_load_dwordx4 v[160:163], v167, s[36:39], s54 offen sc1
    s_add_u32 s54, s54, s55
    buffer_load_dwordx4 v[76:79], v166, s[36:39], s54 offen sc1
    buffer_load_dwordx4 v[80:83], v167, s[36:39], s54 offen sc1
    s_add_u32 s54, s54, s55
    buffer_load_dwordx4 v[92:95], v166, s[36:39], s54 offen sc1
    buffer_load_dwordx4 v[96:99], v167, s[36:39], s54 offen sc1
    s_add_u32 s54, s54, s55
    buffer_load_dwordx4 v[108:111], v166, s[36:39], s54 offen sc1
    buffer_load_dwordx4 v[112:115], v167, s[36:39], s54 offen sc1
    s_add_u32 s54, s54, s55
    buffer_load_dwordx4 v[124:127], v166, s[36:39], s54 offen sc1
    buffer_load_dwordx4 v[128:131], v167, s[36:39], s54 offen sc1
    s_add_u32 s54, s54, s55
    s_waitcnt vmcnt(10)
    v_mfma_f32_32x32x16_bf16 v[4:19], v[132:135], v[140:143], 0
    v_mfma_f32_32x32x16_bf16 v[20:35], v[132:135], v[144:147], 0
    v_mfma_f32_32x32x16_bf16 v[36:51], v[136:139], v[140:143], 0
    v_mfma_f32_32x32x16_bf16 v[52:67], v[136:139], v[144:147], 0
    buffer_load_dwordx4 v[132:135], v164, s[36:39], s54 offen sc1
    buffer_load_dwordx4 v[136:139], v165, s[36:39], s54 offen sc1
    buffer_load_dwordx4 v[140:143], v166, s[36:39], s54 offen sc1
    buffer_load_dwordx4 v[144:147], v167, s[36:39], s54 offen sc1
    s_add_u32 s54, s54, s55
    s_waitcnt vmcnt(12)
    v_mfma_f32_32x32x16_bf16 v[4:19], v[148:151], v[156:159], v[4:19]
    v_mfma_f32_32x32x16_bf16 v[20:35], v[148:151], v[160:163], v[20:35]
    v_mfma_f32_32x32x16_bf16 v[36:51], v[152:155], v[156:159], v[36:51]
    v_mfma_f32_32x32x16_bf16 v[52:67], v[152:155], v[160:163], v[52:67]
    buffer_load_dwordx4 v[148:151], v164, s[36:39], s54 offen sc1
    buffer_load_dwordx4 v[152:155], v165, s[36:39], s54 offen sc1
    buffer_load_dwordx4 v[156:159], v166, s[36:39], s54 offen sc1
    buffer_load_dwordx4 v[160:163], v167, s[36:39], s54 offen sc1
    s_add_u32 s54, s54, s55
    s_waitcnt vmcnt(14)
    v_mfma_f32_32x32x16_bf16 v[4:19], v[68:71], v[76:79], v[4:19]
    v_mfma_f32_32x32x16_bf16 v[20:35], v[68:71], v[80:83], v[20:35]
    v_mfma_f32_32x32x16_bf16 v[36:51], v[72:75], v[76:79], v[36:51]
    v_mfma_f32_32x32x16_bf16 v[52:67], v[72:75], v[80:83], v[52:67]
    buffer_load_dwordx4 v[68:71], v164, s[36:39], s54 offen sc1
    buffer_load_dwordx4 v[72:75], v165, s[36:39], s54 offen sc1
    buffer_load_dwordx4 v[76:79], v166, s[36:39], s54 offen sc1
    buffer_load_dwordx4 v[80:83], v167, s[36:39], s54 offen sc1
    s_add_u32 s54, s54, s55
    s_waitcnt vmcnt(16)
    v_mfma_f32_32x32x16_bf16 v[4:19], v[84:87], v[92:95], v[4:19]
    v_mfma_f32_32x32x16_bf16 v[20:35], v[84:87], v[96:99], v[20:35]
    v_mfma_f32_32x32x16_bf16 v[36:51], v[88:91], v[92:95], v[36:51]
    v_mfma_f32_32x32x16_bf16 v[52:67], v[88:91], v[96:99], v[52:67]
    buffer_load_dwordx4 v[84:87], v164, s[36:39], s54 offen sc1
    buffer_load_dwordx4 v[88:91], v165, s[36:39], s54 offen sc1
    buffer_load_dwordx4 v[92:95], v166, s[36:39], s54 offen sc1
    buffer_load_dwordx4 v[96:99], v167, s[36:39], s54 offen sc1
    s_add_u32 s54, s54, s55
    s_waitcnt vmcnt(18)
    v_mfma_f32_32x32x16_bf16 v[4:19], v[100:103], v[108:111], v[4:19]
    v_mfma_f32_32x32x16_bf16 v[20:35], v[100:103], v[112:115], v[20:35]
    v_mfma_f32_32x32x16_bf16 v[36:51], v[104:107], v[108:111], v[36:51]
    v_mfma_f32_32x32x16_bf16 v[52:67], v[104:107], v[112:115], v[52:67]
    buffer_load_dwordx4 v[100:103], v164, s[36:39], s54 offen sc1
    buffer_load_dwordx4 v[104:107], v165, s[36:39], s54 offen sc1
    buffer_load_dwordx4 v[108:111], v166, s[36:39], s54 offen sc1
    buffer_load_dwordx4 v[112:115], v167, s[36:39], s54 offen sc1
    s_add_u32 s54, s54, s55
    s_waitcnt vmcnt(20)
    v_mfma_f32_32x32x16_bf16 v[4:19], v[116:119], v[124:127], v[4:19]
    v_mfma_f32_32x32x16_bf16 v[20:35], v[116:119], v[128:131], v[20:35]
    v_mfma_f32_32x32x16_bf16 v[36:51], v[120:123], v[124:127], v[36:51]
    v_mfma_f32_32x32x16_bf16 v[52:67], v[120:123], v[128:131], v[52:67]
    buffer_load_dwordx4 v[116:119], v164, s[36:39], s54 offen sc1
    buffer_load_dwordx4 v[120:123], v165, s[36:39], s54 offen sc1
    buffer_load_dwordx4 v[124:127], v166, s[36:39], s54 offen sc1
    buffer_load_dwordx4 v[128:131], v167, s[36:39], s54 offen sc1
    s_add_u32 s54, s54, s55
G_F2L:
    s_waitcnt vmcnt(20)
    v_mfma_f32_32x32x16_bf16 v[4:19], v[132:135], v[140:143], v[4:19]
    v_mfma_f32_32x32x16_bf16 v[20:35], v[132:135], v[144:147], v[20:35]
    v_mfma_f32_32x32x16_bf16 v[36:51], v[136:139], v[140:143], v[36:51]
    v_mfma_f32_32x32x16_bf16 v[52:67], v[136:139], v[144:147], v[52:67]
    buffer_load_dwordx4 v[132:135], v164, s[36:39], s54 offen sc1
    buffer_load_dwordx4 v[136:139], v165, s[36:39], s54 offen sc1
    buffer_load_dwordx4 v[140:143], v166, s[36:39], s54 offen sc1
    buffer_load_dwordx4 v[144:147], v167, s[36:39], s54 offen sc1
    s_add_u32 s54, s54, s55
    s_waitcnt vmcnt(20)
    v_mfma_f32_32x32x16_bf16 v[4:19], v[148:151], v[156:159], v[4:19]
    v_mfma_f32_32x32x16_bf16 v[20:35], v[148:151], v[160:163], v[20:35]
    v_mfma_f32_32x32x16_bf16 v[36:51], v[152:155], v[156:159], v[36:51]
    v_mfma_f32_32x32x16_bf16 v[52:67], v[152:155], v[160:163], v[52:67]
    buffer_load_dwordx4 v[148:151], v164, s[36:39], s54 offen sc1
    buffer_load_dwordx4 v[152:155], v165, s[36:39], s54 offen sc1
    buffer_load_dwordx4 v[156:159], v166, s[36:39], s54 offen sc1
    buffer_load_dwordx4 v[160:163], v167, s[36:39], s54 offen sc1
    s_add_u32 s54, s54, s55
    s_waitcnt vmcnt(20)
    v_mfma_f32_32x32x16_bf16 v[4:19], v[68:71], v[76:79], v[4:19]
    v_mfma_f32_32x32x16_bf16 v[20:35], v[68:71], v[80:83], v[20:35]
    v_mfma_f32_32x32x16_bf16 v[36:51], v[72:75], v[76:79], v[36:51]
    v_mfma_f32_32x32x16_bf16 v[52:67], v[72:75], v[80:83], v[52:67]
WP2931:
    s_cbranch_execz WP3041
    buffer_load_dwordx4 v[68:71], v164, s[36:39], s54 offen sc1
    buffer_load_dwordx4 v[72:75], v165, s[36:39], s54 offen sc1
    buffer_load_dwordx4 v[76:79], v166, s[36:39], s54 offen sc1
    buffer_load_dwordx4 v[80:83], v167, s[36:39], s54 offen sc1
    s_add_u32 s54, s54, s55
    s_waitcnt vmcnt(20)
    v_mfma_f32_32x32x16_bf16 v[4:19], v[84:87], v[92:95], v[4:19]
    v_mfma_f32_32x32x16_bf16 v[20:35], v[84:87], v[96:99], v[20:35]
    v_mfma_f32_32x32x16_bf16 v[36:51], v[88:91], v[92:95], v[36:51]
    v_mfma_f32_32x32x16_bf16 v[52:67], v[88:91], v[96:99], v[52:67]
    buffer_load_dwordx4 v[84:87], v164, s[36:39], s54 offen sc1
    buffer_load_dwordx4 v[88:91], v165, s[36:39], s54 offen sc1
    buffer_load_dwordx4 v[92:95], v166, s[36:39], s54 offen sc1
    buffer_load_dwordx4 v[96:99], v167, s[36:39], s54 offen sc1
    s_add_u32 s54, s54, s55
    s_waitcnt vmcnt(20)
    v_mfma_f32_32x32x16_bf16 v[4:19], v[100:103], v[108:111], v[4:19]
    v_mfma_f32_32x32x16_bf16 v[20:35], v[100:103], v[112:115], v[20:35]
    v_mfma_f32_32x32x16_bf16 v[36:51], v[104:107], v[108:111], v[36:51]
    v_mfma_f32_32x32x16_bf16 v[52:67], v[104:107], v[112:115], v[52:67]
    buffer_load_dwordx4 v[100:103], v164, s[36:39], s54 offen sc1
    buffer_load_dwordx4 v[104:107], v165, s[36:39], s54 offen sc1
    buffer_load_dwordx4 v[108:111], v166, s[36:39], s54 offen sc1
    buffer_load_dwordx4 v[112:115], v167, s[36:39], s54 offen sc1
    s_add_u32 s54, s54, s55
    s_waitcnt vmcnt(20)
    v_mfma_f32_32x32x16_bf16 v[4:19], v[116:119], v[124:127], v[4:19]
    v_mfma_f32_32x32x16_bf16 v[20:35], v[116:119], v[128:131], v[20:35]
    v_mfma_f32_32x32x16_bf16 v[36:51], v[120:123], v[124:127], v[36:51]
    v_mfma_f32_32x32x16_bf16 v[52:67], v[120:123], v[128:131], v[52:67]
    buffer_load_dwordx4 v[116:119], v164, s[36:39], s54 offen sc1
    buffer_load_dwordx4 v[120:123], v165, s[36:39], s54 offen sc1
    buffer_load_dwordx4 v[124:127], v166, s[36:39], s54 offen sc1
    buffer_load_dwordx4 v[128:131], v167, s[36:39], s54 offen sc1
    s_add_u32 s54, s54, s55
    s_sub_u32 s60, s60, 1
    s_cmp_lg_u32 s60, 0
    s_cbranch_scc1 G_F2L
G_F2T:
    s_waitcnt vmcnt(20)
    v_mfma_f32_32x32x16_bf16 v[4:19], v[132:135], v[140:143], v[4:19]
    v_mfma_f32_32x32x16_bf16 v[20:35], v[132:135], v[144:147], v[20:35]
    v_mfma_f32_32x32x16_bf16 v[36:51], v[136:139], v[140:143], v[36:51]
    v_mfma_f32_32x32x16_bf16 v[52:67], v[136:139], v[144:147], v[52:67]
    buffer_load_dwordx4 v[132:135], v164, s[36:39], s54 offen sc1
    buffer_load_dwordx4 v[136:139], v165, s[36:39], s54 offen sc1
    buffer_load_dwordx4 v[140:143], v166, s[36:39], s54 offen sc1
    buffer_load_dwordx4 v[144:147], v167, s[36:39], s54 offen sc1
    s_add_u32 s54, s54, s55
    s_waitcnt vmcnt(20)
    v_mfma_f32_32x32x16_bf16 v[4:19], v[148:151], v[156:159], v[4:19]
    v_mfma_f32_32x32x16_bf16 v[20:35], v[148:151], v[160:163], v[20:35]
    v_mfma_f32_32x32x16_bf16 v[36:51], v[152:155], v[156:159], v[36:51]
    v_mfma_f32_32x32x16_bf16 v[52:67], v[152:155], v[160:163], v[52:67]
    buffer_load_dwordx4 v[148:151], v164, s[36:39], s54 offen sc1
    buffer_load_dwordx4 v[152:155], v165, s[36:39], s54 offen sc1
    buffer_load_dwordx4 v[156:159], v166, s[36:39], s54 offen sc1
    buffer_load_dwordx4 v[160:163], v167, s[36:39], s54 offen sc1
    s_add_u32 s54, s54, s55
    s_waitcnt vmcnt(20)
    v_mfma_f32_32x32x16_bf16 v[4:19], v[68:71], v[76:79], v[4:19]
    v_mfma_f32_32x32x16_bf16 v[20:35], v[68:71], v[80:83], v[20:35]
    v_mfma_f32_32x32x16_bf16 v[36:51], v[72:75], v[76:79], v[36:51]
    v_mfma_f32_32x32x16_bf16 v[52:67], v[72:75], v[80:83], v[52:67]
    s_add_u32 m0, s56, 0xfffff800
    s_nop 0
    buffer_load_dwordx4 v165, s[36:39], s40 offen offset:2048 sc1 lds
    s_add_u32 m0, s56, 0xfffffc00
    s_nop 0
    buffer_load_dwordx4 v164, s[36:39], s41 offen offset:2048 sc1 lds
    s_add_u32 m0, s56, 0x0
    s_nop 0
    buffer_load_dwordx4 v165, s[36:39], s41 offen offset:2048 sc1 lds
    s_add_u32 m0, s56, 0x400
    s_nop 0
    buffer_load_dwordx4 v164, s[36:39], s42 offen offset:2048 sc1 lds
    buffer_load_dwordx4 v[68:71], v164, s[36:39], s40 offen offset:0 sc1
    buffer_load_dwordx4 v[72:75], v165, s[36:39], s40 offen offset:0 sc1
    buffer_load_dwordx4 v[76:79], v164, s[36:39], s41 offen offset:0 sc1
    buffer_load_dwordx4 v[80:83], v165, s[36:39], s41 offen offset:0 sc1
    s_waitcnt vmcnt(24)
    v_mfma_f32_32x32x16_bf16 v[4:19], v[84:87], v[92:95], v[4:19]
    v_mfma_f32_32x32x16_bf16 v[20:35], v[84:87], v[96:99], v[20:35]
    v_mfma_f32_32x32x16_bf16 v[36:51], v[88:91], v[92:95], v[36:51]
    v_mfma_f32_32x32x16_bf16 v[52:67], v[88:91], v[96:99], v[52:67]
    s_add_u32 m0, s56, 0x800
    s_nop 0
    buffer_load_dwordx4 v165, s[36:39], s42 offen offset:2048 sc1 lds
    s_add_u32 m0, s56, 0xc00
    s_nop 0
    buffer_load_dwordx4 v164, s[36:39], s43 offen offset:2048 sc1 lds
    s_add_u32 m0, s56, 0x1000
    s_nop 0
    buffer_load_dwordx4 v165, s[36:39], s43 offen offset:2048 sc1 lds
    buffer_load_dwordx4 v[84:87], v164, s[36:39], s42 offen offset:0 sc1
    buffer_load_dwordx4 v[88:91], v165, s[36:39], s42 offen offset:0 sc1
    buffer_load_dwordx4 v[92:95], v164, s[36:39], s43 offen offset:0 sc1
    buffer_load_dwordx4 v[96:99], v165, s[36:39], s43 offen offset:0 sc1
    s_waitcnt vmcnt(27)
    v_mfma_f32_32x32x16_bf16 v[4:19], v[100:103], v[108:111], v[4:19]
    v_mfma_f32_32x32x16_bf16 v[20:35], v[100:103], v[112:115], v[20:35]
    v_mfma_f32_32x32x16_bf16 v[36:51], v[104:107], v[108:111], v[36:51]
    v_mfma_f32_32x32x16_bf16 v[52:67], v[104:107], v[112:115], v[52:67]
    buffer_load_dwordx4 v[100:103], v164, s[36:39], s40 offen offset:2048 sc1
    s_waitcnt vmcnt(24)
    v_mfma_f32_32x32x16_bf16 v[4:19], v[116:119], v[124:127], v[4:19]
    v_mfma_f32_32x32x16_bf16 v[20:35], v[116:119], v[128:131], v[20:35]
    v_mfma_f32_32x32x16_bf16 v[36:51], v[120:123], v[124:127], v[36:51]
    v_mfma_f32_32x32x16_bf16 v[52:67], v[120:123], v[128:131], v[52:67]
    s_waitcnt vmcnt(20)
WP3041:
    s_cbranch_execz WP3187
    v_mfma_f32_32x32x16_bf16 v[4:19], v[132:135], v[140:143], v[4:19]
    v_mfma_f32_32x32x16_bf16 v[20:35], v[132:135], v[144:147], v[20:35]
    v_mfma_f32_32x32x16_bf16 v[36:51], v[136:139], v[140:143], v[36:51]
    v_mfma_f32_32x32x16_bf16 v[52:67], v[136:139], v[144:147], v[52:67]
    s_waitcnt vmcnt(16)
    v_mfma_f32_32x32x16_bf16 v[4:19], v[148:151], v[156:159], v[4:19]
    v_mfma_f32_32x32x16_bf16 v[20:35], v[148:151], v[160:163], v[20:35]
    v_mfma_f32_32x32x16_bf16 v[36:51], v[152:155], v[156:159], v[36:51]
    v_mfma_f32_32x32x16_bf16 v[52:67], v[152:155], v[160:163], v[52:67]
    s_setprio 3
    s_add_u32 s44, s40, s53
    s_add_u32 s45, s41, s53
    s_add_u32 s46, s42, s53
    s_add_u32 s47, s43, s53
    s_add_u32 s48, s44, 120832
    s_add_u32 s49, s45, 120832
    s_add_u32 s50, s46, 120832
    s_add_u32 s51, s47, 120832
    s_mov_b32 s58, 0x8000
    s_mov_b32 s57, 0xff
    s_mov_b32 s59, 0
    s_mov_b64 s[66:67], 0
    v_add_u32 v1, s56, v2
    s_mov_b32 s31, 0x40000
SP_27:
    ds_read_b32 v0, v3 offset:44
    s_sub_u32 s31, s31, 1
    s_waitcnt lgkmcnt(0)
    v_readfirstlane_b32 s30, v0
    s_cbranch_scc1 SP_27_X
    s_cmp_ge_u32 s30, 64
    s_cbranch_scc1 SP_27_X
    s_sleep 1
    s_branch SP_27
SP_27_X:
    s_waitcnt vmcnt(0)
    buffer_load_dwordx4 v[104:107], v2, s[36:39], s44 offen offset:0 sc1
    buffer_load_dwordx4 v[108:111], v2, s[36:39], s48 offen offset:0 sc1
    buffer_load_dwordx4 v[112:115], v2, s[36:39], s45 offen offset:0 sc1
    buffer_load_dwordx4 v[116:119], v2, s[36:39], s49 offen offset:0 sc1
    buffer_load_dwordx4 v[120:123], v2, s[36:39], s46 offen offset:0 sc1
    buffer_load_dwordx4 v[124:127], v2, s[36:39], s50 offen offset:0 sc1
    buffer_load_dwordx4 v[128:131], v2, s[36:39], s47 offen offset:0 sc1
    buffer_load_dwordx4 v[132:135], v2, s[36:39], s51 offen offset:0 sc1
    s_cmp_ge_u32 s30, 72
    s_cbranch_scc1 G_OLATE
    s_mov_b32 s57, 15
    s_mov_b64 s[66:67], -1
G_OP1:
    s_sub_u32 s58, s58, 1
    s_waitcnt vmcnt(0)
    ds_read_b32 v164, v3 offset:44
    s_cbranch_scc1 G_OBI
G_OP2:
    s_bitcmp1_b32 s57, 0
    s_cbranch_scc0 G_OPN0
    v_max3_u32 v0, v104, v105, v106
    v_max3_u32 v0, v107, v108, v0
    v_max3_u32 v0, v109, v110, v0
    v_max_u32 v0, v111, v0
    v_cmp_eq_u32 vcc, -1, v0
    s_bitset0_b32 s57, 0
    s_cbranch_vccz G_OPN0
    s_bitset1_b32 s57, 0
    buffer_load_dwordx4 v[104:107], v2, s[36:39], s44 offen offset:0 sc1
    buffer_load_dwordx4 v[108:111], v2, s[36:39], s48 offen offset:0 sc1
G_OPN0:
    s_bitcmp1_b32 s57, 1
    s_cbranch_scc0 G_OPN1
    v_max3_u32 v0, v112, v113, v114
    v_max3_u32 v0, v115, v116, v0
    v_max3_u32 v0, v117, v118, v0
    v_max_u32 v0, v119, v0
    v_cmp_eq_u32 vcc, -1, v0
    s_bitset0_b32 s57, 1
    s_cbranch_vccz G_OPN1
    s_bitset1_b32 s57, 1
    buffer_load_dwordx4 v[112:115], v2, s[36:39], s45 offen offset:0 sc1
    buffer_load_dwordx4 v[116:119], v2, s[36:39], s49 offen offset:0 sc1
G_OPN1:
    s_bitcmp1_b32 s57, 2
    s_cbranch_scc0 G_OPN2
    v_max3_u32 v0, v120, v121, v122
    v_max3_u32 v0, v123, v124, v0
    v_max3_u32 v0, v125, v126, v0
    v_max_u32 v0, v127, v0
    v_cmp_eq_u32 vcc, -1, v0
    s_bitset0_b32 s57, 2
    s_cbranch_vccz G_OPN2
    s_bitset1_b32 s57, 2
    buffer_load_dwordx4 v[120:123], v2, s[36:39], s46 offen offset:0 sc1
    buffer_load_dwordx4 v[124:127], v2, s[36:39], s50 offen offset:0 sc1
G_OPN2:
    s_bitcmp1_b32 s57, 3
    s_cbranch_scc0 G_OPN3
    v_max3_u32 v0, v128, v129, v130
    v_max3_u32 v0, v131, v132, v0
    v_max3_u32 v0, v133, v134, v0
    v_max_u32 v0, v135, v0
    v_cmp_eq_u32 vcc, -1, v0
    s_bitset0_b32 s57, 3
    s_cbranch_vccz G_OPN3
    s_bitset1_b32 s57, 3
    buffer_load_dwordx4 v[128:131], v2, s[36:39], s47 offen offset:0 sc1
    buffer_load_dwordx4 v[132:135], v2, s[36:39], s51 offen offset:0 sc1
G_OPN3:
    s_bitcmp1_b32 s57, s59
    s_cselect_b64 vcc, -1, 0
    s_cmp_eq_u32 s66, 0
    s_cbranch_scc1 G_ORX
G_OB:
    s_waitcnt lgkmcnt(0)
    v_readfirstlane_b32 s30, v164
    s_cmp_ge_u32 s30, 72
    s_cbranch_scc1 G_OBI
    s_cbranch_vccnz G_OP1
    s_cmp_eq_u32 s59, 0
    s_cbranch_scc1 G_OV0
    s_cmp_eq_u32 s59, 1
    s_cbranch_scc1 G_OV1
    s_cmp_eq_u32 s59, 2
    s_cbranch_scc1 G_OV2
    s_cmp_eq_u32 s59, 3
    s_cbranch_scc1 G_OV3
    s_mov_b32 s31, 0x40000
SP_28:
    ds_read_b32 v0, v3 offset:44
    s_sub_u32 s31, s31, 1
    s_waitcnt lgkmcnt(0)
    v_readfirstlane_b32 s30, v0
    s_cbranch_scc1 SP_28_X
    s_cmp_ge_u32 s30, 72
    s_cbranch_scc1 SP_28_X
    s_sleep 1
    s_branch SP_28
SP_28_X:
G_OBI:
    s_waitcnt lgkmcnt(0)
    buffer_load_dwordx4 v[136:139], v2, s[36:39], s44 offen offset:2048 sc1
    buffer_load_dwordx4 v[140:143], v2, s[36:39], s48 offen offset:2048 sc1
    buffer_load_dwordx4 v[144:147], v2, s[36:39], s45 offen offset:2048 sc1
    buffer_load_dwordx4 v[148:151], v2, s[36:39], s49 offen offset:2048 sc1
    buffer_load_dwordx4 v[152:155], v2, s[36:39], s46 offen offset:2048 sc1
    buffer_load_dwordx4 v[156:159], v2, s[36:39], s50 offen offset:2048 sc1
    buffer_load_dwordx4 v[160:163], v2, s[36:39], s47 offen offset:2048 sc1
    buffer_load_dwordx4 v[164:167], v2, s[36:39], s51 offen offset:2048 sc1
WP3187:
    s_cbranch_execz WP3335
    s_mov_b64 s[66:67], 0
    s_bitcmp1_b32 s57, s59
    s_cselect_b64 vcc, -1, 0
    s_or_b32 s57, s57, 0xf0
    s_cmp_lt_u32 s59, 4
    s_cbranch_scc0 G_OB4
    s_cbranch_vccz G_ODIS
    s_waitcnt vmcnt(8)
    s_branch G_OP2
G_OB4:
    s_waitcnt vmcnt(6)
    v_max3_u32 v0, v136, v137, v138
    v_max3_u32 v0, v139, v140, v0
    v_max3_u32 v0, v141, v142, v0
    v_max_u32 v0, v143, v0
    v_cmp_eq_u32 vcc, -1, v0
    s_cbranch_vccz G_OV4
    s_branch G_OREF
G_OLATE:
    buffer_load_dwordx4 v[136:139], v2, s[36:39], s44 offen offset:2048 sc1
    buffer_load_dwordx4 v[140:143], v2, s[36:39], s48 offen offset:2048 sc1
    buffer_load_dwordx4 v[144:147], v2, s[36:39], s45 offen offset:2048 sc1
    buffer_load_dwordx4 v[148:151], v2, s[36:39], s49 offen offset:2048 sc1
    buffer_load_dwordx4 v[152:155], v2, s[36:39], s46 offen offset:2048 sc1
    buffer_load_dwordx4 v[156:159], v2, s[36:39], s50 offen offset:2048 sc1
    buffer_load_dwordx4 v[160:163], v2, s[36:39], s47 offen offset:2048 sc1
    buffer_load_dwordx4 v[164:167], v2, s[36:39], s51 offen offset:2048 sc1
    s_waitcnt vmcnt(14)
    v_max3_u32 v0, v104, v105, v106
    v_max3_u32 v0, v107, v108, v0
    v_max3_u32 v0, v109, v110, v0
    v_max_u32 v0, v111, v0
    v_cmp_eq_u32 vcc, -1, v0
    s_cbranch_vccz G_OV0
G_OREF:
    s_sub_u32 s58, s58, 1
    s_cbranch_scc1 G_OEND
    s_and_b32 s30, s57, 15
    s_cbranch_scc0 G_ORN3
    s_bitcmp1_b32 s57, 0
    s_cbranch_scc0 G_ORN0
    s_waitcnt vmcnt(14)
    v_max3_u32 v0, v104, v105, v106
    v_max3_u32 v0, v107, v108, v0
    v_max3_u32 v0, v109, v110, v0
    v_max_u32 v0, v111, v0
    v_cmp_eq_u32 vcc, -1, v0
    s_bitset0_b32 s57, 0
    s_cbranch_vccz G_ORN0
    s_bitset1_b32 s57, 0
    buffer_load_dwordx4 v[104:107], v2, s[36:39], s44 offen offset:0 sc1
    buffer_load_dwordx4 v[108:111], v2, s[36:39], s48 offen offset:0 sc1
G_ORN0:
    s_bitcmp1_b32 s57, 1
    s_cbranch_scc0 G_ORN1
    s_waitcnt vmcnt(12)
    v_max3_u32 v0, v112, v113, v114
    v_max3_u32 v0, v115, v116, v0
    v_max3_u32 v0, v117, v118, v0
    v_max_u32 v0, v119, v0
    v_cmp_eq_u32 vcc, -1, v0
    s_bitset0_b32 s57, 1
    s_cbranch_vccz G_ORN1
    s_bitset1_b32 s57, 1
    buffer_load_dwordx4 v[112:115], v2, s[36:39], s45 offen offset:0 sc1
    buffer_load_dwordx4 v[116:119], v2, s[36:39], s49 offen offset:0 sc1
G_ORN1:
    s_bitcmp1_b32 s57, 2
    s_cbranch_scc0 G_ORN2
    s_waitcnt vmcnt(10)
    v_max3_u32 v0, v120, v121, v122
    v_max3_u32 v0, v123, v124, v0
    v_max3_u32 v0, v125, v126, v0
    v_max_u32 v0, v127, v0
    v_cmp_eq_u32 vcc, -1, v0
    s_bitset0_b32 s57, 2
    s_cbranch_vccz G_ORN2
    s_bitset1_b32 s57, 2
    buffer_load_dwordx4 v[120:123], v2, s[36:39], s46 offen offset:0 sc1
    buffer_load_dwordx4 v[124:127], v2, s[36:39], s50 offen offset:0 sc1
G_ORN2:
    s_bitcmp1_b32 s57, 3
    s_cbranch_scc0 G_ORN3
    s_waitcnt vmcnt(8)
    v_max3_u32 v0, v128, v129, v130
    v_max3_u32 v0, v131, v132, v0
    v_max3_u32 v0, v133, v134, v0
    v_max_u32 v0, v135, v0
    v_cmp_eq_u32 vcc, -1, v0
    s_bitset0_b32 s57, 3
    s_cbranch_vccz G_ORN3
    s_bitset1_b32 s57, 3
    buffer_load_dwordx4 v[128:131], v2, s[36:39], s47 offen offset:0 sc1
    buffer_load_dwordx4 v[132:135], v2, s[36:39], s51 offen offset:0 sc1
G_ORN3:
    s_bitcmp1_b32 s57, 4
    s_cbranch_scc0 G_ORN4
    s_waitcnt vmcnt(6)
    v_max3_u32 v0, v136, v137, v138
    v_max3_u32 v0, v139, v140, v0
    v_max3_u32 v0, v141, v142, v0
    v_max_u32 v0, v143, v0
    v_cmp_eq_u32 vcc, -1, v0
    s_bitset0_b32 s57, 4
    s_cbranch_vccz G_ORN4
    s_bitset1_b32 s57, 4
    buffer_load_dwordx4 v[136:139], v2, s[36:39], s44 offen offset:2048 sc1
    buffer_load_dwordx4 v[140:143], v2, s[36:39], s48 offen offset:2048 sc1
G_ORN4:
    s_bitcmp1_b32 s57, 5
    s_cbranch_scc0 G_ORN5
    s_waitcnt vmcnt(4)
    v_max3_u32 v0, v144, v145, v146
    v_max3_u32 v0, v147, v148, v0
    v_max3_u32 v0, v149, v150, v0
    v_max_u32 v0, v151, v0
    v_cmp_eq_u32 vcc, -1, v0
    s_bitset0_b32 s57, 5
    s_cbranch_vccz G_ORN5
    s_bitset1_b32 s57, 5
    buffer_load_dwordx4 v[144:147], v2, s[36:39], s45 offen offset:2048 sc1
    buffer_load_dwordx4 v[148:151], v2, s[36:39], s49 offen offset:2048 sc1
G_ORN5:
    s_bitcmp1_b32 s57, 6
    s_cbranch_scc0 G_ORN6
    s_waitcnt vmcnt(2)
    v_max3_u32 v0, v152, v153, v154
    v_max3_u32 v0, v155, v156, v0
    v_max3_u32 v0, v157, v158, v0
    v_max_u32 v0, v159, v0
    v_cmp_eq_u32 vcc, -1, v0
    s_bitset0_b32 s57, 6
    s_cbranch_vccz G_ORN6
    s_bitset1_b32 s57, 6
    buffer_load_dwordx4 v[152:155], v2, s[36:39], s46 offen offset:2048 sc1
    buffer_load_dwordx4 v[156:159], v2, s[36:39], s50 offen offset:2048 sc1
G_ORN6:
    s_bitcmp1_b32 s57, 7
    s_cbranch_scc0 G_ORN7
    s_waitcnt vmcnt(0)
    v_max3_u32 v0, v160, v161, v162
    v_max3_u32 v0, v163, v164, v0
    v_max3_u32 v0, v165, v166, v0
    v_max_u32 v0, v167, v0
    v_cmp_eq_u32 vcc, -1, v0
    s_bitset0_b32 s57, 7
    s_cbranch_vccz G_ORN7
    s_bitset1_b32 s57, 7
WP3335:
    s_cbranch_execz WP3491
    buffer_load_dwordx4 v[160:163], v2, s[36:39], s47 offen offset:2048 sc1
    buffer_load_dwordx4 v[164:167], v2, s[36:39], s51 offen offset:2048 sc1
G_ORN7:
G_ORX:
    s_bitcmp1_b32 s57, s59
    s_cbranch_scc1 G_OREF
G_ODIS:
    s_cmp_eq_u32 s59, 7
    s_cbranch_scc1 G_OV7
    s_cmp_eq_u32 s59, 6
    s_cbranch_scc1 G_OV6
    s_cmp_eq_u32 s59, 5
    s_cbranch_scc1 G_OV5
    s_cmp_eq_u32 s59, 4
    s_cbranch_scc1 G_OV4
    s_cmp_eq_u32 s59, 3
    s_cbranch_scc1 G_OV3
    s_cmp_eq_u32 s59, 2
    s_cbranch_scc1 G_OV2
    s_cmp_eq_u32 s59, 1
    s_cbranch_scc1 G_OV1
G_OV0:
    v_mfma_f32_32x32x16_bf16 v[4:19], v[68:71], v[104:107], v[4:19]
    s_bitset0_b32 s57, 0
    s_mov_b32 s59, 1
    s_mov_b64 vcc, 0
    v_mfma_f32_32x32x16_bf16 v[20:35], v[68:71], v[108:111], v[20:35]
    s_cmp_eq_u32 s66, 0
    s_cbranch_scc1 G_OQ0
    ds_read_b32 v164, v3 offset:44
G_OQ0:
    s_bitcmp1_b32 s57, 1
    ds_read_b128 v[68:71], v1 offset:0
    v_mfma_f32_32x32x16_bf16 v[36:51], v[72:75], v[104:107], v[36:51]
    s_cbranch_scc0 G_OK0
    s_waitcnt vmcnt(12)
    v_max3_u32 v0, v112, v113, v114
    v_max3_u32 v0, v115, v116, v0
    v_max3_u32 v0, v117, v118, v0
    v_max_u32 v0, v119, v0
    v_cmp_eq_u32 vcc, -1, v0
G_OK0:
    v_mfma_f32_32x32x16_bf16 v[52:67], v[72:75], v[108:111], v[52:67]
    ds_read_b128 v[72:75], v1 offset:1024
    s_cmp_lg_u32 s66, 0
    s_cbranch_scc1 G_OB
    s_cbranch_vccnz G_OREF
G_OV1:
    v_mfma_f32_32x32x16_bf16 v[4:19], v[76:79], v[112:115], v[4:19]
    s_bitset0_b32 s57, 1
    s_mov_b32 s59, 2
    s_mov_b64 vcc, 0
    v_mfma_f32_32x32x16_bf16 v[20:35], v[76:79], v[116:119], v[20:35]
    s_cmp_eq_u32 s66, 0
    s_cbranch_scc1 G_OQ1
    ds_read_b32 v164, v3 offset:44
G_OQ1:
    s_bitcmp1_b32 s57, 2
    ds_read_b128 v[76:79], v1 offset:2048
    v_mfma_f32_32x32x16_bf16 v[36:51], v[80:83], v[112:115], v[36:51]
    s_cbranch_scc0 G_OK1
    s_waitcnt vmcnt(10)
    v_max3_u32 v0, v120, v121, v122
    v_max3_u32 v0, v123, v124, v0
    v_max3_u32 v0, v125, v126, v0
    v_max_u32 v0, v127, v0
    v_cmp_eq_u32 vcc, -1, v0
G_OK1:
    v_mfma_f32_32x32x16_bf16 v[52:67], v[80:83], v[116:119], v[52:67]
    ds_read_b128 v[80:83], v1 offset:3072
    s_cmp_lg_u32 s66, 0
    s_cbranch_scc1 G_OB
    s_cbranch_vccnz G_OREF
G_OV2:
    v_mfma_f32_32x32x16_bf16 v[4:19], v[84:87], v[120:123], v[4:19]
    s_bitset0_b32 s57, 2
    s_mov_b32 s59, 3
    s_mov_b64 vcc, 0
    v_mfma_f32_32x32x16_bf16 v[20:35], v[84:87], v[124:127], v[20:35]
    s_cmp_eq_u32 s66, 0
    s_cbranch_scc1 G_OQ2
    ds_read_b32 v164, v3 offset:44
G_OQ2:
    s_bitcmp1_b32 s57, 3
    ds_read_b128 v[84:87], v1 offset:4096
    v_mfma_f32_32x32x16_bf16 v[36:51], v[88:91], v[120:123], v[36:51]
    s_cbranch_scc0 G_OK2
    s_waitcnt vmcnt(8)
    v_max3_u32 v0, v128, v129, v130
    v_max3_u32 v0, v131, v132, v0
    v_max3_u32 v0, v133, v134, v0
    v_max_u32 v0, v135, v0
    v_cmp_eq_u32 vcc, -1, v0
G_OK2:
    v_mfma_f32_32x32x16_bf16 v[52:67], v[88:91], v[124:127], v[52:67]
    ds_read_b128 v[88:91], v1 offset:5120
    s_cmp_lg_u32 s66, 0
    s_cbranch_scc1 G_OB
    s_cbranch_vccnz G_OREF
G_OV3:
    v_mfma_f32_32x32x16_bf16 v[4:19], v[92:95], v[128:131], v[4:19]
    s_bitset0_b32 s57, 3
    s_mov_b32 s59, 4
    s_mov_b64 vcc, 0
    v_mfma_f32_32x32x16_bf16 v[20:35], v[92:95], v[132:135], v[20:35]
    s_cmp_eq_u32 s66, 0
    s_cbranch_scc1 G_OQ3
    ds_read_b32 v164, v3 offset:44
G_OQ3:
    s_bitcmp1_b32 s57, 4
    ds_read_b128 v[92:95], v1 offset:6144
    v_mfma_f32_32x32x16_bf16 v[36:51], v[96:99], v[128:131], v[36:51]
    s_cbranch_scc0 G_OK3
    s_waitcnt vmcnt(6)
    v_max3_u32 v0, v136, v137, v138
    v_max3_u32 v0, v139, v140, v0
    v_max3_u32 v0, v141, v142, v0
    v_max_u32 v0, v143, v0
    v_cmp_eq_u32 vcc, -1, v0
G_OK3:
    v_mfma_f32_32x32x16_bf16 v[52:67], v[96:99], v[132:135], v[52:67]
    s_cmp_lg_u32 s66, 0
    s_cbranch_scc1 G_OB
    s_cbranch_vccnz G_OREF
G_OV4:
    s_waitcnt lgkmcnt(6)
    v_mfma_f32_32x32x16_bf16 v[4:19], v[100:103], v[136:139], v[4:19]
    s_bitset0_b32 s57, 4
    s_mov_b32 s59, 5
    s_mov_b64 vcc, 0
    s_bitcmp1_b32 s57, 5
    v_mfma_f32_32x32x16_bf16 v[20:35], v[100:103], v[140:143], v[20:35]
    v_mfma_f32_32x32x16_bf16 v[36:51], v[68:71], v[136:139], v[36:51]
    s_cbranch_scc0 G_OK4
    s_waitcnt vmcnt(4)
    v_max3_u32 v0, v144, v145, v146
    v_max3_u32 v0, v147, v148, v0
    v_max3_u32 v0, v149, v150, v0
    v_max_u32 v0, v151, v0
    v_cmp_eq_u32 vcc, -1, v0
G_OK4:
    v_mfma_f32_32x32x16_bf16 v[52:67], v[68:71], v[140:143], v[52:67]
    s_cbranch_vccnz G_OREF
G_OV5:
    s_waitcnt lgkmcnt(4)
    v_mfma_f32_32x32x16_bf16 v[4:19], v[72:75], v[144:147], v[4:19]
    s_bitset0_b32 s57, 5
    s_mov_b32 s59, 6
    s_mov_b64 vcc, 0
    s_bitcmp1_b32 s57, 6
    v_mfma_f32_32x32x16_bf16 v[20:35], v[72:75], v[148:151], v[20:35]
    v_mfma_f32_32x32x16_bf16 v[36:51], v[76:79], v[144:147], v[36:51]
    s_cbranch_scc0 G_OK5
    s_waitcnt vmcnt(2)
    v_max3_u32 v0, v152, v153, v154
    v_max3_u32 v0, v155, v156, v0
WP3491:
    s_cbranch_execz WP935
    v_max3_u32 v0, v157, v158, v0
    v_max_u32 v0, v159, v0
    v_cmp_eq_u32 vcc, -1, v0
G_OK5:
    v_mfma_f32_32x32x16_bf16 v[52:67], v[76:79], v[148:151], v[52:67]
    s_cbranch_vccnz G_OREF
G_OV6:
    s_waitcnt lgkmcnt(2)
    v_mfma_f32_32x32x16_bf16 v[4:19], v[80:83], v[152:155], v[4:19]
    s_bitset0_b32 s57, 6
    s_mov_b32 s59, 7
    s_mov_b64 vcc, 0
    s_bitcmp1_b32 s57, 7
    v_mfma_f32_32x32x16_bf16 v[20:35], v[80:83], v[156:159], v[20:35]
    v_mfma_f32_32x32x16_bf16 v[36:51], v[84:87], v[152:155], v[36:51]
    s_cbranch_scc0 G_OK6
    s_waitcnt vmcnt(0)
    v_max3_u32 v0, v160, v161, v162
    v_max3_u32 v0, v163, v164, v0
    v_max3_u32 v0, v165, v166, v0
    v_max_u32 v0, v167, v0
    v_cmp_eq_u32 vcc, -1, v0
G_OK6:
    v_mfma_f32_32x32x16_bf16 v[52:67], v[84:87], v[156:159], v[52:67]
    s_cbranch_vccnz G_OREF
G_OV7:
G_OEND:
    s_waitcnt lgkmcnt(0)
    v_mfma_f32_32x32x16_bf16 v[4:19], v[88:91], v[160:163], v[4:19]
    v_lshrrev_b32 v0, 4, v2
    ds_read_b32 v1, v3 offset:44
    v_and_b32 v2, 31, v0
    s_nop 0
    v_mfma_f32_32x32x16_bf16 v[20:35], v[88:91], v[164:167], v[20:35]
    v_mul_u32_u24 v2, 272, v2
    v_lshrrev_b32 v0, 5, v0
    s_mul_i32 s52, s62, 17408
    v_lshl_add_u32 v2, v0, 4, v2
    v_mfma_f32_32x32x16_bf16 v[36:51], v[92:95], v[160:163], v[36:51]
    v_add_u32 v2, s52, v2
    s_waitcnt lgkmcnt(0)
    v_readfirstlane_b32 s30, v1
    s_cmp_ge_u32 s30, 72
    v_mfma_f32_32x32x16_bf16 v[52:67], v[92:95], v[164:167], v[52:67]
    s_cbranch_scc1 G_OW
    s_mov_b32 s31, 0x40000
SP_29:
    ds_read_b32 v1, v3 offset:44
    s_sub_u32 s31, s31, 1
    s_waitcnt lgkmcnt(0)
    v_readfirstlane_b32 s30, v1
    s_cbranch_scc1 SP_29_X
    s_cmp_ge_u32 s30, 72
    s_cbranch_scc1 SP_29_X
    s_sleep 1
    s_branch SP_29
SP_29_X:
G_OW:
    ds_write_b128 v2, v[4:7] offset:0
    ds_write_b128 v2, v[8:11] offset:32
    ds_write_b128 v2, v[12:15] offset:64
    ds_write_b128 v2, v[16:19] offset:96
    ds_write_b128 v2, v[20:23] offset:8704
    ds_write_b128 v2, v[24:27] offset:8736
    ds_write_b128 v2, v[28:31] offset:8768
    ds_write_b128 v2, v[32:35] offset:8800
    ds_write_b128 v2, v[36:39] offset:128
    ds_write_b128 v2, v[40:43] offset:160
    ds_write_b128 v2, v[44:47] offset:192
    ds_write_b128 v2, v[48:51] offset:224
    ds_write_b128 v2, v[52:55] offset:8832
    ds_write_b128 v2, v[56:59] offset:8864
    ds_write_b128 v2, v[60:63] offset:8896
    ds_write_b128 v2, v[64:67] offset:8928
    s_waitcnt lgkmcnt(0)
    s_barrier
    s_cmp_eq_u32 s2, 0
    s_cselect_b32 s52, s62, 0
    s_cmp_eq_u32 s52, 3
    s_cbranch_scc0 G_END
    s_mov_b32 s52, 0x0
    v_mov_b32 v4, s61
    v_mov_b32 v5, 0
    s_mov_b64 exec, 1
    buffer_store_dword v4, v5, s[36:39], s52 offen sc1
    s_mov_b64 exec, -1
G_END:
    s_waitcnt vmcnt(0)
DONE:
    s_endpgm
.section .rodata,"a"
.p2align 6
.amdhsa_kernel parallel_sum__grouped_kv_mqa__dense_activation_relu__prompt_kernel
  .amdhsa_next_free_vgpr 168
  .amdhsa_next_free_sgpr 102
  .amdhsa_accum_offset 168
  .amdhsa_group_segment_fixed_size 0
  .amdhsa_kernarg_size 88
  .amdhsa_user_sgpr_count 2
  .amdhsa_user_sgpr_kernarg_segment_ptr 1
  .amdhsa_system_sgpr_workgroup_id_x 1
  .amdhsa_float_denorm_mode_32 3
.end_amdhsa_kernel
```
